```python
import torch

def _softmax(x, axis=-1):
    return torch.softmax(x, dim=axis)
def _gelu(x):
    return torch.nn.functional.gelu(x, approximate="tanh")
def _silu(x):
    return torch.nn.functional.silu(x)
def _sigmoid(x):
    return torch.sigmoid(x)
def _layernorm(x, axis=-1, eps=1e-5):
    m = x.mean(dim=axis, keepdim=True)
    v = x.var(dim=axis, keepdim=True, unbiased=False)
    return (x - m) / torch.sqrt(v + eps)
def _scatter_add(tgt, idx, src, axis=0):
    return tgt.clone().index_add_(axis, idx, src)
def _segment_sum(src, seg, n):
    out = torch.zeros((n,) + src.shape[1:], dtype=src.dtype)
    return out.index_add_(0, seg, src)
def _pad(x, pw):
    flat = tuple(v for pair in reversed(pw) for v in pair)
    return torch.nn.functional.pad(x, flat)

kernel_name = 'interleave_layers__linear_kernel_hedgehog__glu_gated_glu__prompt'

def setup_inputs():

    _w = (lambda a: (lambda t: t.to(torch.bfloat16) if t.is_floating_point() else t)(torch.as_tensor(a)))
    def _A_setup():
        B, S, D, H = 1, 2048, 448, 16
        Dh = D // H
        return {
            "x": _w((lambda *s: torch.randn(*s, dtype=torch.bfloat16) * 0.05)(B, S, D)),
            "wqkv": _w((lambda *s: torch.randn(*s, dtype=torch.bfloat16) * 0.4)(D, 3 * D)),
            "w_phi": _w((lambda *s: torch.randn(*s, dtype=torch.bfloat16) * 0.4)(H, Dh, Dh) * (Dh ** -0.5)),
            "wo": _w((lambda *s: torch.randn(*s, dtype=torch.bfloat16) * 0.05)(D, D)),
        }
    _A_in = _A_setup()

    def _B_setup():
        B, S, D, F = 1, 2048, 448, 1792
        return {
            "x": _w((lambda *s: torch.randn(*s, dtype=torch.bfloat16) * 0.05)(B, S, D)),
            "w_gate": _w((lambda *s: torch.randn(*s, dtype=torch.bfloat16) * 0.05)(D, F)),
            "w_up": _w((lambda *s: torch.randn(*s, dtype=torch.bfloat16) * 0.05)(D, F)),
            "w_down": _w((lambda *s: torch.randn(*s, dtype=torch.bfloat16) * 0.05)(F, D)),
        }
    _B_in = _B_setup()

    return {
        "A_x": _A_in["x"],
        "A_wqkv": _A_in["wqkv"],
        "A_w_phi": _A_in["w_phi"],
        "A_wo": _A_in["wo"],
        "B_x": _B_in["x"],
        "B_w_gate": _B_in["w_gate"],
        "B_w_up": _B_in["w_up"],
        "B_w_down": _B_in["w_down"],
    }

def reference(A_x, A_wqkv, A_w_phi, A_wo, B_x, B_w_gate, B_w_up, B_w_down):
    def _A_ref(x, wqkv, w_phi, wo):
        B, S, D = x.shape
        H = 16; Dh = D // H
        qkv = (lambda x, *d: x.permute(*d))((x @ wqkv).reshape(B, S, 3, H, Dh), 2, 0, 3, 1, 4)
        q, k, v = qkv[0], qkv[1], qkv[2]
        pq = torch.einsum("bhsd,hdf->bhsf", q, w_phi)
        pk = torch.einsum("bhsd,hdf->bhsf", k, w_phi)
        phi_q = torch.concatenate([_softmax(pq, axis=-1), _softmax(-pq, axis=-1)], axis=-1)
        phi_k = torch.concatenate([_softmax(pk, axis=-1), _softmax(-pk, axis=-1)], axis=-1)
        kv = torch.einsum("bhsf,bhsd->bhfd", phi_k, v)
        z  = torch.einsum("bhsf->bhf", phi_k)
        num = torch.einsum("bhqf,bhfd->bhqd", phi_q, kv)
        den = torch.einsum("bhqf,bhf->bhq", phi_q, z)[..., None] + 1e-6
        o = num / den
        return (lambda x, *d: x.permute(*d))(o, 0, 2, 1, 3).reshape(B, S, D) @ wo

    def _B_ref(x, w_gate, w_up, w_down):
        g = torch.einsum("bsd,df->bsf", x, w_gate)
        u = torch.einsum("bsd,df->bsf", x, w_up)
        h = _sigmoid(g) * u
        return torch.einsum("bsf,fd->bsd", h, w_down)

    x = A_x
    x = x + _A_ref(_layernorm(x, axis=-1), A_wqkv, A_w_phi, A_wo)
    x = x + _B_ref(_layernorm(x, axis=-1), B_w_gate, B_w_up, B_w_down)
    x = x + _A_ref(_layernorm(x, axis=-1), A_wqkv, A_w_phi, A_wo)
    x = x + _B_ref(_layernorm(x, axis=-1), B_w_gate, B_w_up, B_w_down)
    return x
```

```asm
; @launch kernel=k0_kernel grid=(652,1,1) block=(256,1,1) lds=512
; @launch kernel=mega_kernel grid=(256,1,1) block=(512,1,1) lds=131072
.amdgcn_target "amdgcn-amd-amdhsa--gfx950"
.text
.globl k0_kernel
.p2align 8
.type k0_kernel,@function
k0_kernel:
    s_cmp_ge_u32 s2, 652
    s_cbranch_scc1 K0_END
    s_load_dwordx16 s[4:19], s[0:1], 0
    s_load_dwordx4 s[20:23], s[0:1], 64
    s_load_dwordx2 s[24:25], s[0:1], 80
    s_waitcnt lgkmcnt(0)
    s_mov_b32 s28, s24
    s_and_b32 s29, s25, 0xffff
    s_mov_b32 s30, 268435456
    s_mov_b32 s31, 0x00020000
    v_lshrrev_b32 v1, 6, v0
    v_and_b32 v2, 63, v0
    s_nop 0
    v_readfirstlane_b32 s3, v1
    s_lshl_b32 s26, s2, 2
    s_add_u32 s26, s26, s3
    v_and_b32 v3, 31, v2
    v_lshrrev_b32 v4, 5, v2
    v_bfe_u32 v5, v3, 2, 1
    v_lshlrev_b32 v5, 4, v5
    v_lshrrev_b32 v6, 3, v3
    v_lshl_add_u32 v5, v6, 2, v5
    v_and_b32 v6, 3, v3
    v_add_u32 v5, v5, v6
    v_lshlrev_b32 v30, 4, v2
    v_mov_b32 v31, 0x7ffffff0
    s_cmp_lt_u32 s26, 640
    s_cbranch_scc1 K0_CS
    s_sub_u32 s26, s26, 640
    s_cmp_lt_u32 s26, 256
    s_cbranch_scc1 K0_X
    s_sub_u32 s26, s26, 256
    s_cmp_ge_u32 s26, 1632
    s_cbranch_scc1 K0_ZERO
    s_lshl_b32 s26, s26, 2
    s_cmp_ge_u32 s26, 4960
    s_cbranch_scc1 K0_WD
    s_cmp_ge_u32 s26, 1824
    s_cbranch_scc1 K0_WGU
    s_cmp_ge_u32 s26, 1376
    s_cbranch_scc1 K0_WO
    s_cmp_ge_u32 s26, 1344
    s_cbranch_scc1 K0_WPHI
    s_mov_b32 s32, s6
    s_and_b32 s33, s7, 0xffff
    s_mov_b32 s34, 1204224
    s_mov_b32 s35, 0x00020000
    s_mov_b32 s36, 0x924924a
    s_mul_hi_u32 s37, s26, s36
    s_mul_i32 s38, s37, 28
    s_sub_u32 s38, s26, s38
    s_mov_b32 s36, 0x55555556
    s_mul_hi_u32 s39, s37, s36
    s_mul_i32 s40, s39, 3
    s_sub_u32 s40, s37, s40
    s_mul_i32 s41, s38, 16*2688
    s_mul_i32 s42, s40, 896
    s_add_u32 s41, s41, s42
    s_mul_i32 s42, s39, 56
    s_add_u32 s41, s41, s42
    v_mul_u32_u24 v6, 8*2688, v4
    v_lshl_add_u32 v6, v3, 1, v6
    v_add_u32 v6, s41, v6
    v_cmp_gt_u32 vcc, 28, v3
    s_nop 1
    v_cndmask_b32 v6, v31, v6, vcc
    v_add_u32 v8, 0, v6
    buffer_load_ushort v32, v8, s[32:35], 0 offen
    v_add_u32 v8, 2688, v6
    buffer_load_ushort v33, v8, s[32:35], 0 offen
    v_add_u32 v8, 5376, v6
    buffer_load_ushort v34, v8, s[32:35], 0 offen
    v_add_u32 v8, 8064, v6
    buffer_load_ushort v35, v8, s[32:35], 0 offen
    v_add_u32 v8, 10752, v6
    buffer_load_ushort v36, v8, s[32:35], 0 offen
    v_add_u32 v8, 13440, v6
    buffer_load_ushort v37, v8, s[32:35], 0 offen
    v_add_u32 v8, 16128, v6
    buffer_load_ushort v38, v8, s[32:35], 0 offen
    v_add_u32 v8, 18816, v6
    buffer_load_ushort v39, v8, s[32:35], 0 offen
    v_add_u32 v8, 43008, v6
    buffer_load_ushort v40, v8, s[32:35], 0 offen
    v_add_u32 v8, 45696, v6
    buffer_load_ushort v41, v8, s[32:35], 0 offen
    v_add_u32 v8, 48384, v6
    buffer_load_ushort v42, v8, s[32:35], 0 offen
    v_add_u32 v8, 51072, v6
    buffer_load_ushort v43, v8, s[32:35], 0 offen
    v_add_u32 v8, 53760, v6
    buffer_load_ushort v44, v8, s[32:35], 0 offen
    v_add_u32 v8, 56448, v6
    buffer_load_ushort v45, v8, s[32:35], 0 offen
    v_add_u32 v8, 59136, v6
    buffer_load_ushort v46, v8, s[32:35], 0 offen
    v_add_u32 v8, 61824, v6
    buffer_load_ushort v47, v8, s[32:35], 0 offen
    v_add_u32 v8, 86016, v6
    buffer_load_ushort v48, v8, s[32:35], 0 offen
    v_add_u32 v8, 88704, v6
    buffer_load_ushort v49, v8, s[32:35], 0 offen
    v_add_u32 v8, 91392, v6
    buffer_load_ushort v50, v8, s[32:35], 0 offen
    v_add_u32 v8, 94080, v6
    buffer_load_ushort v51, v8, s[32:35], 0 offen
    v_add_u32 v8, 96768, v6
    buffer_load_ushort v52, v8, s[32:35], 0 offen
    v_add_u32 v8, 99456, v6
    buffer_load_ushort v53, v8, s[32:35], 0 offen
    v_add_u32 v8, 102144, v6
    buffer_load_ushort v54, v8, s[32:35], 0 offen
    v_add_u32 v8, 104832, v6
    buffer_load_ushort v55, v8, s[32:35], 0 offen
    v_add_u32 v8, 129024, v6
    buffer_load_ushort v56, v8, s[32:35], 0 offen
    v_add_u32 v8, 131712, v6
    buffer_load_ushort v57, v8, s[32:35], 0 offen
    v_add_u32 v8, 134400, v6
    buffer_load_ushort v58, v8, s[32:35], 0 offen
    v_add_u32 v8, 137088, v6
    buffer_load_ushort v59, v8, s[32:35], 0 offen
    v_add_u32 v8, 139776, v6
    buffer_load_ushort v60, v8, s[32:35], 0 offen
    v_add_u32 v8, 142464, v6
    buffer_load_ushort v61, v8, s[32:35], 0 offen
    v_add_u32 v8, 145152, v6
    buffer_load_ushort v62, v8, s[32:35], 0 offen
    v_add_u32 v8, 147840, v6
    buffer_load_ushort v63, v8, s[32:35], 0 offen
    s_add_u32 s43, s26, 0
    s_branch K0_STORE
K0_WPHI:
    s_mov_b32 s32, s8
    s_and_b32 s33, s9, 0xffff
    s_mov_b32 s34, 25088
    s_mov_b32 s35, 0x00020000
    s_sub_u32 s36, s26, 1344
    s_lshr_b32 s37, s36, 1
    s_mul_i32 s41, s37, 1568
    v_mul_u32_u24 v6, 4*56, v4
    v_lshl_add_u32 v6, v3, 1, v6
    v_add_u32 v6, s41, v6
    v_cmp_gt_u32 vcc, 28, v3
    s_nop 1
    v_cndmask_b32 v6, v31, v6, vcc
    v_cmp_eq_u32 vcc, 0, v4
    s_nop 1
    v_cndmask_b32 v7, v31, v6, vcc
    v_add_u32 v8, 0, v6
    buffer_load_ushort v32, v8, s[32:35], 0 offen
    v_add_u32 v8, 56, v6
    buffer_load_ushort v33, v8, s[32:35], 0 offen
    v_add_u32 v8, 112, v6
    buffer_load_ushort v34, v8, s[32:35], 0 offen
    v_add_u32 v8, 168, v6
    buffer_load_ushort v35, v8, s[32:35], 0 offen
    v_add_u32 v8, 448, v6
    buffer_load_ushort v36, v8, s[32:35], 0 offen
    v_add_u32 v8, 504, v6
    buffer_load_ushort v37, v8, s[32:35], 0 offen
    v_add_u32 v8, 560, v6
    buffer_load_ushort v38, v8, s[32:35], 0 offen
    v_add_u32 v8, 616, v6
    buffer_load_ushort v39, v8, s[32:35], 0 offen
    v_add_u32 v8, 896, v6
    buffer_load_ushort v40, v8, s[32:35], 0 offen
    v_add_u32 v8, 952, v6
    buffer_load_ushort v41, v8, s[32:35], 0 offen
    v_add_u32 v8, 1008, v6
    buffer_load_ushort v42, v8, s[32:35], 0 offen
    v_add_u32 v8, 1064, v6
    buffer_load_ushort v43, v8, s[32:35], 0 offen
    v_add_u32 v8, 1344, v7
    buffer_load_ushort v44, v8, s[32:35], 0 offen
    v_add_u32 v8, 1400, v7
    buffer_load_ushort v45, v8, s[32:35], 0 offen
    v_add_u32 v8, 1456, v7
    buffer_load_ushort v46, v8, s[32:35], 0 offen
    v_add_u32 v8, 1512, v7
    buffer_load_ushort v47, v8, s[32:35], 0 offen
    v_add_u32 v8, 1568, v6
    buffer_load_ushort v48, v8, s[32:35], 0 offen
    v_add_u32 v8, 1624, v6
    buffer_load_ushort v49, v8, s[32:35], 0 offen
    v_add_u32 v8, 1680, v6
    buffer_load_ushort v50, v8, s[32:35], 0 offen
    v_add_u32 v8, 1736, v6
    buffer_load_ushort v51, v8, s[32:35], 0 offen
    v_add_u32 v8, 2016, v6
    buffer_load_ushort v52, v8, s[32:35], 0 offen
    v_add_u32 v8, 2072, v6
    buffer_load_ushort v53, v8, s[32:35], 0 offen
    v_add_u32 v8, 2128, v6
    buffer_load_ushort v54, v8, s[32:35], 0 offen
    v_add_u32 v8, 2184, v6
    buffer_load_ushort v55, v8, s[32:35], 0 offen
    v_add_u32 v8, 2464, v6
    buffer_load_ushort v56, v8, s[32:35], 0 offen
    v_add_u32 v8, 2520, v6
    buffer_load_ushort v57, v8, s[32:35], 0 offen
    v_add_u32 v8, 2576, v6
    buffer_load_ushort v58, v8, s[32:35], 0 offen
    v_add_u32 v8, 2632, v6
    buffer_load_ushort v59, v8, s[32:35], 0 offen
    v_add_u32 v8, 2912, v7
    buffer_load_ushort v60, v8, s[32:35], 0 offen
    v_add_u32 v8, 2968, v7
    buffer_load_ushort v61, v8, s[32:35], 0 offen
    v_add_u32 v8, 3024, v7
    buffer_load_ushort v62, v8, s[32:35], 0 offen
    v_add_u32 v8, 3080, v7
    buffer_load_ushort v63, v8, s[32:35], 0 offen
    s_add_u32 s43, s36, 1344
    s_branch K0_STORE
K0_WO:
    s_mov_b32 s32, s10
    s_and_b32 s33, s11, 0xffff
    s_mov_b32 s34, 401408
    s_mov_b32 s35, 0x00020000
    s_sub_u32 s36, s26, 1376
    s_lshr_b32 s37, s36, 1
    s_and_b32 s39, s37, 15
    s_lshr_b32 s40, s37, 4
    s_mul_i32 s41, s39, 28*896
    s_lshl_b32 s42, s40, 6
    s_add_u32 s41, s41, s42
    v_mul_u32_u24 v6, 4*896, v4
    v_lshl_add_u32 v6, v5, 1, v6
    v_add_u32 v6, s41, v6
    v_cmp_eq_u32 vcc, 0, v4
    s_nop 1
    v_cndmask_b32 v7, v31, v6, vcc
    v_add_u32 v8, 0, v6
    buffer_load_ushort v32, v8, s[32:35], 0 offen
    v_add_u32 v8, 896, v6
    buffer_load_ushort v33, v8, s[32:35], 0 offen
    v_add_u32 v8, 1792, v6
    buffer_load_ushort v34, v8, s[32:35], 0 offen
    v_add_u32 v8, 2688, v6
    buffer_load_ushort v35, v8, s[32:35], 0 offen
    v_add_u32 v8, 7168, v6
    buffer_load_ushort v36, v8, s[32:35], 0 offen
    v_add_u32 v8, 8064, v6
    buffer_load_ushort v37, v8, s[32:35], 0 offen
    v_add_u32 v8, 8960, v6
    buffer_load_ushort v38, v8, s[32:35], 0 offen
    v_add_u32 v8, 9856, v6
    buffer_load_ushort v39, v8, s[32:35], 0 offen
    v_add_u32 v8, 14336, v6
    buffer_load_ushort v40, v8, s[32:35], 0 offen
    v_add_u32 v8, 15232, v6
    buffer_load_ushort v41, v8, s[32:35], 0 offen
    v_add_u32 v8, 16128, v6
    buffer_load_ushort v42, v8, s[32:35], 0 offen
    v_add_u32 v8, 17024, v6
    buffer_load_ushort v43, v8, s[32:35], 0 offen
    v_add_u32 v8, 21504, v7
    buffer_load_ushort v44, v8, s[32:35], 0 offen
    v_add_u32 v8, 22400, v7
    buffer_load_ushort v45, v8, s[32:35], 0 offen
    v_add_u32 v8, 23296, v7
    buffer_load_ushort v46, v8, s[32:35], 0 offen
    v_add_u32 v8, 24192, v7
    buffer_load_ushort v47, v8, s[32:35], 0 offen
    v_add_u32 v8, 25088, v6
    buffer_load_ushort v48, v8, s[32:35], 0 offen
    v_add_u32 v8, 25984, v6
    buffer_load_ushort v49, v8, s[32:35], 0 offen
    v_add_u32 v8, 26880, v6
    buffer_load_ushort v50, v8, s[32:35], 0 offen
    v_add_u32 v8, 27776, v6
    buffer_load_ushort v51, v8, s[32:35], 0 offen
    v_add_u32 v8, 32256, v6
    buffer_load_ushort v52, v8, s[32:35], 0 offen
    v_add_u32 v8, 33152, v6
    buffer_load_ushort v53, v8, s[32:35], 0 offen
    v_add_u32 v8, 34048, v6
    buffer_load_ushort v54, v8, s[32:35], 0 offen
    v_add_u32 v8, 34944, v6
    buffer_load_ushort v55, v8, s[32:35], 0 offen
    v_add_u32 v8, 39424, v6
    buffer_load_ushort v56, v8, s[32:35], 0 offen
    v_add_u32 v8, 40320, v6
    buffer_load_ushort v57, v8, s[32:35], 0 offen
    v_add_u32 v8, 41216, v6
    buffer_load_ushort v58, v8, s[32:35], 0 offen
    v_add_u32 v8, 42112, v6
    buffer_load_ushort v59, v8, s[32:35], 0 offen
    v_add_u32 v8, 46592, v7
    buffer_load_ushort v60, v8, s[32:35], 0 offen
    v_add_u32 v8, 47488, v7
    buffer_load_ushort v61, v8, s[32:35], 0 offen
    v_add_u32 v8, 48384, v7
    buffer_load_ushort v62, v8, s[32:35], 0 offen
    v_add_u32 v8, 49280, v7
    buffer_load_ushort v63, v8, s[32:35], 0 offen
    s_add_u32 s43, s36, 1376
    s_branch K0_STORE
K0_WGU:
    s_sub_u32 s36, s26, 1824
    s_lshr_b32 s37, s36, 1
    s_mov_b32 s39, 0x924924a
    s_mul_hi_u32 s39, s37, s39
    s_mul_i32 s40, s39, 28
    s_sub_u32 s40, s37, s40
    s_mov_b32 s32, s14
    s_and_b32 s33, s15, 0xffff
    s_mov_b32 s34, 1605632
    s_mov_b32 s35, 0x00020000
    s_mov_b32 s44, s16
    s_and_b32 s45, s17, 0xffff
    s_mov_b32 s46, 1605632
    s_mov_b32 s47, 0x00020000
    s_mul_i32 s41, s40, 16*3584
    s_lshl_b32 s42, s39, 6
    s_add_u32 s41, s41, s42
    v_mul_u32_u24 v6, 8*3584, v4
    v_lshl_add_u32 v6, v3, 1, v6
    v_add_u32 v6, s41, v6
    v_add_u32 v8, 0, v6
    buffer_load_ushort v32, v8, s[32:35], 0 offen
    v_add_u32 v8, 3584, v6
    buffer_load_ushort v33, v8, s[32:35], 0 offen
    v_add_u32 v8, 7168, v6
    buffer_load_ushort v34, v8, s[32:35], 0 offen
    v_add_u32 v8, 10752, v6
    buffer_load_ushort v35, v8, s[32:35], 0 offen
    v_add_u32 v8, 14336, v6
    buffer_load_ushort v36, v8, s[32:35], 0 offen
    v_add_u32 v8, 17920, v6
    buffer_load_ushort v37, v8, s[32:35], 0 offen
    v_add_u32 v8, 21504, v6
    buffer_load_ushort v38, v8, s[32:35], 0 offen
    v_add_u32 v8, 25088, v6
    buffer_load_ushort v39, v8, s[32:35], 0 offen
    v_add_u32 v8, 0, v6
    buffer_load_ushort v40, v8, s[44:47], 0 offen
    v_add_u32 v8, 3584, v6
    buffer_load_ushort v41, v8, s[44:47], 0 offen
    v_add_u32 v8, 7168, v6
    buffer_load_ushort v42, v8, s[44:47], 0 offen
    v_add_u32 v8, 10752, v6
    buffer_load_ushort v43, v8, s[44:47], 0 offen
    v_add_u32 v8, 14336, v6
    buffer_load_ushort v44, v8, s[44:47], 0 offen
    v_add_u32 v8, 17920, v6
    buffer_load_ushort v45, v8, s[44:47], 0 offen
    v_add_u32 v8, 21504, v6
    buffer_load_ushort v46, v8, s[44:47], 0 offen
    v_add_u32 v8, 25088, v6
    buffer_load_ushort v47, v8, s[44:47], 0 offen
    v_add_u32 v8, 57344, v6
    buffer_load_ushort v48, v8, s[32:35], 0 offen
    v_add_u32 v8, 60928, v6
    buffer_load_ushort v49, v8, s[32:35], 0 offen
    v_add_u32 v8, 64512, v6
    buffer_load_ushort v50, v8, s[32:35], 0 offen
    v_add_u32 v8, 68096, v6
    buffer_load_ushort v51, v8, s[32:35], 0 offen
    v_add_u32 v8, 71680, v6
    buffer_load_ushort v52, v8, s[32:35], 0 offen
    v_add_u32 v8, 75264, v6
    buffer_load_ushort v53, v8, s[32:35], 0 offen
    v_add_u32 v8, 78848, v6
    buffer_load_ushort v54, v8, s[32:35], 0 offen
    v_add_u32 v8, 82432, v6
    buffer_load_ushort v55, v8, s[32:35], 0 offen
    v_add_u32 v8, 57344, v6
    buffer_load_ushort v56, v8, s[44:47], 0 offen
    v_add_u32 v8, 60928, v6
    buffer_load_ushort v57, v8, s[44:47], 0 offen
    v_add_u32 v8, 64512, v6
    buffer_load_ushort v58, v8, s[44:47], 0 offen
    v_add_u32 v8, 68096, v6
    buffer_load_ushort v59, v8, s[44:47], 0 offen
    v_add_u32 v8, 71680, v6
    buffer_load_ushort v60, v8, s[44:47], 0 offen
    v_add_u32 v8, 75264, v6
    buffer_load_ushort v61, v8, s[44:47], 0 offen
    v_add_u32 v8, 78848, v6
    buffer_load_ushort v62, v8, s[44:47], 0 offen
    v_add_u32 v8, 82432, v6
    buffer_load_ushort v63, v8, s[44:47], 0 offen
    s_add_u32 s43, s36, 1824
    s_branch K0_STORE
K0_WD:
    s_mov_b32 s32, s18
    s_and_b32 s33, s19, 0xffff
    s_mov_b32 s34, 1605632
    s_mov_b32 s35, 0x00020000
    s_sub_u32 s36, s26, 4960
    s_lshr_b32 s37, s36, 1
    s_mov_b32 s39, 0x4924925
    s_mul_hi_u32 s39, s37, s39
    s_mul_i32 s40, s39, 56
    s_sub_u32 s40, s37, s40
    s_mul_i32 s41, s40, 32*896
    s_lshl_b32 s42, s39, 6
    s_add_u32 s41, s41, s42
    v_mul_u32_u24 v6, 4*896, v4
    v_lshl_add_u32 v6, v5, 1, v6
    v_add_u32 v6, s41, v6
    v_add_u32 v8, 0, v6
    buffer_load_ushort v32, v8, s[32:35], 0 offen
    v_add_u32 v8, 896, v6
    buffer_load_ushort v33, v8, s[32:35], 0 offen
    v_add_u32 v8, 1792, v6
    buffer_load_ushort v34, v8, s[32:35], 0 offen
    v_add_u32 v8, 2688, v6
    buffer_load_ushort v35, v8, s[32:35], 0 offen
    v_add_u32 v8, 7168, v6
    buffer_load_ushort v36, v8, s[32:35], 0 offen
    v_add_u32 v8, 8064, v6
    buffer_load_ushort v37, v8, s[32:35], 0 offen
    v_add_u32 v8, 8960, v6
    buffer_load_ushort v38, v8, s[32:35], 0 offen
    v_add_u32 v8, 9856, v6
    buffer_load_ushort v39, v8, s[32:35], 0 offen
    v_add_u32 v8, 14336, v6
    buffer_load_ushort v40, v8, s[32:35], 0 offen
    v_add_u32 v8, 15232, v6
    buffer_load_ushort v41, v8, s[32:35], 0 offen
    v_add_u32 v8, 16128, v6
    buffer_load_ushort v42, v8, s[32:35], 0 offen
    v_add_u32 v8, 17024, v6
    buffer_load_ushort v43, v8, s[32:35], 0 offen
    v_add_u32 v8, 21504, v6
    buffer_load_ushort v44, v8, s[32:35], 0 offen
    v_add_u32 v8, 22400, v6
    buffer_load_ushort v45, v8, s[32:35], 0 offen
    v_add_u32 v8, 23296, v6
    buffer_load_ushort v46, v8, s[32:35], 0 offen
    v_add_u32 v8, 24192, v6
    buffer_load_ushort v47, v8, s[32:35], 0 offen
    v_add_u32 v8, 28672, v6
    buffer_load_ushort v48, v8, s[32:35], 0 offen
    v_add_u32 v8, 29568, v6
    buffer_load_ushort v49, v8, s[32:35], 0 offen
    v_add_u32 v8, 30464, v6
    buffer_load_ushort v50, v8, s[32:35], 0 offen
    v_add_u32 v8, 31360, v6
    buffer_load_ushort v51, v8, s[32:35], 0 offen
    v_add_u32 v8, 35840, v6
    buffer_load_ushort v52, v8, s[32:35], 0 offen
    v_add_u32 v8, 36736, v6
    buffer_load_ushort v53, v8, s[32:35], 0 offen
    v_add_u32 v8, 37632, v6
    buffer_load_ushort v54, v8, s[32:35], 0 offen
    v_add_u32 v8, 38528, v6
    buffer_load_ushort v55, v8, s[32:35], 0 offen
    v_add_u32 v8, 43008, v6
    buffer_load_ushort v56, v8, s[32:35], 0 offen
    v_add_u32 v8, 43904, v6
    buffer_load_ushort v57, v8, s[32:35], 0 offen
    v_add_u32 v8, 44800, v6
    buffer_load_ushort v58, v8, s[32:35], 0 offen
    v_add_u32 v8, 45696, v6
    buffer_load_ushort v59, v8, s[32:35], 0 offen
    v_add_u32 v8, 50176, v6
    buffer_load_ushort v60, v8, s[32:35], 0 offen
    v_add_u32 v8, 51072, v6
    buffer_load_ushort v61, v8, s[32:35], 0 offen
    v_add_u32 v8, 51968, v6
    buffer_load_ushort v62, v8, s[32:35], 0 offen
    v_add_u32 v8, 52864, v6
    buffer_load_ushort v63, v8, s[32:35], 0 offen
    s_add_u32 s43, s36, 4960
K0_STORE:
    s_lshl_b32 s43, s43, 10
    s_waitcnt vmcnt(24)
    v_lshl_or_b32 v32, v33, 16, v32
    v_lshl_or_b32 v33, v35, 16, v34
    v_lshl_or_b32 v34, v37, 16, v36
    v_lshl_or_b32 v35, v39, 16, v38
    buffer_store_dwordx4 v[32:35], v30, s[28:31], s43 offen offset:0
    s_waitcnt vmcnt(17)
    v_lshl_or_b32 v40, v41, 16, v40
    v_lshl_or_b32 v41, v43, 16, v42
    v_lshl_or_b32 v42, v45, 16, v44
    v_lshl_or_b32 v43, v47, 16, v46
    buffer_store_dwordx4 v[40:43], v30, s[28:31], s43 offen offset:1024
    s_waitcnt vmcnt(10)
    v_lshl_or_b32 v48, v49, 16, v48
    v_lshl_or_b32 v49, v51, 16, v50
    v_lshl_or_b32 v50, v53, 16, v52
    v_lshl_or_b32 v51, v55, 16, v54
    buffer_store_dwordx4 v[48:51], v30, s[28:31], s43 offen offset:2048
    s_waitcnt vmcnt(3)
    v_lshl_or_b32 v56, v57, 16, v56
    v_lshl_or_b32 v57, v59, 16, v58
    v_lshl_or_b32 v58, v61, 16, v60
    v_lshl_or_b32 v59, v63, 16, v62
    buffer_store_dwordx4 v[56:59], v30, s[28:31], s43 offen offset:3072
    s_endpgm
K0_ZERO:
    s_sub_u32 s36, s26, 1632
    s_cmp_ge_u32 s36, 80
    s_cbranch_scc1 K0_END
    s_cmp_ge_u32 s36, 76
    s_cselect_b32 s37, 4, 0
    s_add_u32 s36, s36, s37
    s_lshl_b32 s36, s36, 12
    s_add_u32 s36, s36, 6684672
    v_mov_b32 v24, 0
    v_mov_b32 v25, 0
    v_mov_b32 v26, 0
    v_mov_b32 v27, 0
    buffer_store_dwordx4 v[24:27], v30, s[28:31], s36 offen offset:0
    buffer_store_dwordx4 v[24:27], v30, s[28:31], s36 offen offset:1024
    buffer_store_dwordx4 v[24:27], v30, s[28:31], s36 offen offset:2048
    buffer_store_dwordx4 v[24:27], v30, s[28:31], s36 offen offset:3072
    s_endpgm
K0_X:
    s_mov_b32 s32, s4
    s_and_b32 s33, s5, 0xffff
    s_mov_b32 s34, 1835008
    s_mov_b32 s35, 0x00020000
    v_lshrrev_b32 v3, 3, v2
    v_and_b32 v4, 7, v2
    s_mul_i32 s36, s26, 8*896
    v_mul_u32_u24 v5, 896, v3
    v_lshl_add_u32 v5, v4, 4, v5
    buffer_load_dwordx4 v[32:35], v5, s[32:35], s36 offen offset:0
    buffer_load_dwordx4 v[36:39], v5, s[32:35], s36 offen offset:128
    buffer_load_dwordx4 v[40:43], v5, s[32:35], s36 offen offset:256
    buffer_load_dwordx4 v[44:47], v5, s[32:35], s36 offen offset:384
    buffer_load_dwordx4 v[48:51], v5, s[32:35], s36 offen offset:512
    buffer_load_dwordx4 v[52:55], v5, s[32:35], s36 offen offset:640
    buffer_load_dwordx4 v[56:59], v5, s[32:35], s36 offen offset:768
    s_lshr_b32 s37, s26, 2
    s_mul_i32 s37, s37, 28672
    s_add_u32 s37, s37, 15704064
    s_and_b32 s38, s26, 3
    s_lshl_b32 s38, s38, 7
    s_add_u32 s37, s37, s38
    v_lshrrev_b32 v6, 1, v4
    v_lshlrev_b32 v6, 10, v6
    v_and_b32 v7, 1, v4
    v_lshl_add_u32 v6, v7, 9, v6
    v_lshl_add_u32 v6, v3, 4, v6
    s_waitcnt vmcnt(0)
    s_add_u32 s38, s37, 0
    buffer_store_dwordx4 v[32:35], v6, s[28:31], s38 offen
    s_add_u32 s38, s37, 4096
    buffer_store_dwordx4 v[36:39], v6, s[28:31], s38 offen
    s_add_u32 s38, s37, 8192
    buffer_store_dwordx4 v[40:43], v6, s[28:31], s38 offen
    s_add_u32 s38, s37, 12288
    buffer_store_dwordx4 v[44:47], v6, s[28:31], s38 offen
    s_add_u32 s38, s37, 16384
    buffer_store_dwordx4 v[48:51], v6, s[28:31], s38 offen
    s_add_u32 s38, s37, 20480
    buffer_store_dwordx4 v[52:55], v6, s[28:31], s38 offen
    s_add_u32 s38, s37, 24576
    buffer_store_dwordx4 v[56:59], v6, s[28:31], s38 offen
    v_mov_b32 v8, 0
    v_mov_b32 v9, 0
    v_mov_b32 v10, 0
    v_mov_b32 v11, 0
    v_lshlrev_b32 v12, 16, v32
    v_and_b32 v13, 0xffff0000, v32
    v_pk_add_f32 v[8:9], v[8:9], v[12:13]
    v_pk_fma_f32 v[10:11], v[12:13], v[12:13], v[10:11]
    v_lshlrev_b32 v12, 16, v33
    v_and_b32 v13, 0xffff0000, v33
    v_pk_add_f32 v[8:9], v[8:9], v[12:13]
    v_pk_fma_f32 v[10:11], v[12:13], v[12:13], v[10:11]
    v_lshlrev_b32 v12, 16, v34
    v_and_b32 v13, 0xffff0000, v34
    v_pk_add_f32 v[8:9], v[8:9], v[12:13]
    v_pk_fma_f32 v[10:11], v[12:13], v[12:13], v[10:11]
    v_lshlrev_b32 v12, 16, v35
    v_and_b32 v13, 0xffff0000, v35
    v_pk_add_f32 v[8:9], v[8:9], v[12:13]
    v_pk_fma_f32 v[10:11], v[12:13], v[12:13], v[10:11]
    v_lshlrev_b32 v12, 16, v36
    v_and_b32 v13, 0xffff0000, v36
    v_pk_add_f32 v[8:9], v[8:9], v[12:13]
    v_pk_fma_f32 v[10:11], v[12:13], v[12:13], v[10:11]
    v_lshlrev_b32 v12, 16, v37
    v_and_b32 v13, 0xffff0000, v37
    v_pk_add_f32 v[8:9], v[8:9], v[12:13]
    v_pk_fma_f32 v[10:11], v[12:13], v[12:13], v[10:11]
    v_lshlrev_b32 v12, 16, v38
    v_and_b32 v13, 0xffff0000, v38
    v_pk_add_f32 v[8:9], v[8:9], v[12:13]
    v_pk_fma_f32 v[10:11], v[12:13], v[12:13], v[10:11]
    v_lshlrev_b32 v12, 16, v39
    v_and_b32 v13, 0xffff0000, v39
    v_pk_add_f32 v[8:9], v[8:9], v[12:13]
    v_pk_fma_f32 v[10:11], v[12:13], v[12:13], v[10:11]
    v_lshlrev_b32 v12, 16, v40
    v_and_b32 v13, 0xffff0000, v40
    v_pk_add_f32 v[8:9], v[8:9], v[12:13]
    v_pk_fma_f32 v[10:11], v[12:13], v[12:13], v[10:11]
    v_lshlrev_b32 v12, 16, v41
    v_and_b32 v13, 0xffff0000, v41
    v_pk_add_f32 v[8:9], v[8:9], v[12:13]
    v_pk_fma_f32 v[10:11], v[12:13], v[12:13], v[10:11]
    v_lshlrev_b32 v12, 16, v42
    v_and_b32 v13, 0xffff0000, v42
    v_pk_add_f32 v[8:9], v[8:9], v[12:13]
    v_pk_fma_f32 v[10:11], v[12:13], v[12:13], v[10:11]
    v_lshlrev_b32 v12, 16, v43
    v_and_b32 v13, 0xffff0000, v43
    v_pk_add_f32 v[8:9], v[8:9], v[12:13]
    v_pk_fma_f32 v[10:11], v[12:13], v[12:13], v[10:11]
    v_lshlrev_b32 v12, 16, v44
    v_and_b32 v13, 0xffff0000, v44
    v_pk_add_f32 v[8:9], v[8:9], v[12:13]
    v_pk_fma_f32 v[10:11], v[12:13], v[12:13], v[10:11]
    v_lshlrev_b32 v12, 16, v45
    v_and_b32 v13, 0xffff0000, v45
    v_pk_add_f32 v[8:9], v[8:9], v[12:13]
    v_pk_fma_f32 v[10:11], v[12:13], v[12:13], v[10:11]
    v_lshlrev_b32 v12, 16, v46
    v_and_b32 v13, 0xffff0000, v46
    v_pk_add_f32 v[8:9], v[8:9], v[12:13]
    v_pk_fma_f32 v[10:11], v[12:13], v[12:13], v[10:11]
    v_lshlrev_b32 v12, 16, v47
    v_and_b32 v13, 0xffff0000, v47
    v_pk_add_f32 v[8:9], v[8:9], v[12:13]
    v_pk_fma_f32 v[10:11], v[12:13], v[12:13], v[10:11]
    v_lshlrev_b32 v12, 16, v48
    v_and_b32 v13, 0xffff0000, v48
    v_pk_add_f32 v[8:9], v[8:9], v[12:13]
    v_pk_fma_f32 v[10:11], v[12:13], v[12:13], v[10:11]
    v_lshlrev_b32 v12, 16, v49
    v_and_b32 v13, 0xffff0000, v49
    v_pk_add_f32 v[8:9], v[8:9], v[12:13]
    v_pk_fma_f32 v[10:11], v[12:13], v[12:13], v[10:11]
    v_lshlrev_b32 v12, 16, v50
    v_and_b32 v13, 0xffff0000, v50
    v_pk_add_f32 v[8:9], v[8:9], v[12:13]
    v_pk_fma_f32 v[10:11], v[12:13], v[12:13], v[10:11]
    v_lshlrev_b32 v12, 16, v51
    v_and_b32 v13, 0xffff0000, v51
    v_pk_add_f32 v[8:9], v[8:9], v[12:13]
    v_pk_fma_f32 v[10:11], v[12:13], v[12:13], v[10:11]
    v_lshlrev_b32 v12, 16, v52
    v_and_b32 v13, 0xffff0000, v52
    v_pk_add_f32 v[8:9], v[8:9], v[12:13]
    v_pk_fma_f32 v[10:11], v[12:13], v[12:13], v[10:11]
    v_lshlrev_b32 v12, 16, v53
    v_and_b32 v13, 0xffff0000, v53
    v_pk_add_f32 v[8:9], v[8:9], v[12:13]
    v_pk_fma_f32 v[10:11], v[12:13], v[12:13], v[10:11]
    v_lshlrev_b32 v12, 16, v54
    v_and_b32 v13, 0xffff0000, v54
    v_pk_add_f32 v[8:9], v[8:9], v[12:13]
    v_pk_fma_f32 v[10:11], v[12:13], v[12:13], v[10:11]
    v_lshlrev_b32 v12, 16, v55
    v_and_b32 v13, 0xffff0000, v55
    v_pk_add_f32 v[8:9], v[8:9], v[12:13]
    v_pk_fma_f32 v[10:11], v[12:13], v[12:13], v[10:11]
    v_lshlrev_b32 v12, 16, v56
    v_and_b32 v13, 0xffff0000, v56
    v_pk_add_f32 v[8:9], v[8:9], v[12:13]
    v_pk_fma_f32 v[10:11], v[12:13], v[12:13], v[10:11]
    v_lshlrev_b32 v12, 16, v57
    v_and_b32 v13, 0xffff0000, v57
    v_pk_add_f32 v[8:9], v[8:9], v[12:13]
    v_pk_fma_f32 v[10:11], v[12:13], v[12:13], v[10:11]
    v_lshlrev_b32 v12, 16, v58
    v_and_b32 v13, 0xffff0000, v58
    v_pk_add_f32 v[8:9], v[8:9], v[12:13]
    v_pk_fma_f32 v[10:11], v[12:13], v[12:13], v[10:11]
    v_lshlrev_b32 v12, 16, v59
    v_and_b32 v13, 0xffff0000, v59
    v_pk_add_f32 v[8:9], v[8:9], v[12:13]
    v_pk_fma_f32 v[10:11], v[12:13], v[12:13], v[10:11]
    v_add_f32 v8, v8, v9
    v_add_f32 v9, v10, v11
    s_nop 1
    v_add_f32_dpp v8, v8, v8 quad_perm:[1,0,3,2] row_mask:0xf bank_mask:0xf
    s_nop 1
    v_add_f32_dpp v8, v8, v8 quad_perm:[2,3,0,1] row_mask:0xf bank_mask:0xf
    s_nop 1
    v_add_f32_dpp v8, v8, v8 row_half_mirror row_mask:0xf bank_mask:0xf
    s_nop 1
    v_add_f32_dpp v9, v9, v9 quad_perm:[1,0,3,2] row_mask:0xf bank_mask:0xf
    s_nop 1
    v_add_f32_dpp v9, v9, v9 quad_perm:[2,3,0,1] row_mask:0xf bank_mask:0xf
    s_nop 1
    v_add_f32_dpp v9, v9, v9 row_half_mirror row_mask:0xf bank_mask:0xf
    s_lshl_b32 s38, s26, 6
    s_add_u32 s38, s38, 6995968
    v_lshlrev_b32 v6, 3, v3
    buffer_store_dwordx2 v[8:9], v6, s[28:31], s38 offen
    s_endpgm
K0_CS:
    v_and_b32 v3, 7, v2
    v_lshrrev_b32 v4, 3, v2
    s_lshl_b32 s37, s3, 3
    v_add_u32 v4, s37, v4
    s_cmp_ge_u32 s2, 48
    s_cbranch_scc1 K0_CS_GU
    s_mov_b32 s32, s6
    s_and_b32 s33, s7, 0xffff
    s_mov_b32 s34, 1204224
    s_mov_b32 s35, 0x00020000
    s_mov_b32 s36, 0x55555556
    s_mul_hi_u32 s39, s2, s36
    s_mul_i32 s40, s39, 3
    s_sub_u32 s40, s2, s40
    s_mul_i32 s41, s40, 896
    s_mul_i32 s42, s39, 56
    s_add_u32 s41, s41, s42
    s_mov_b32 s42, 2688
    v_mul_u32_u24 v6, 14*2688, v4
    v_lshl_add_u32 v6, v3, 3, v6
    v_add_u32 v6, s41, v6
    v_cmp_gt_u32 vcc, 7, v3
    s_nop 1
    v_cndmask_b32 v6, v31, v6, vcc
    s_lshl_b32 s43, s2, 7
    s_add_u32 s43, s43, 7290880
    s_branch K0_CS_GO
K0_CS_GU:
    s_sub_u32 s36, s2, 48
    s_and_b32 s38, s36, 1
    s_lshr_b32 s39, s36, 1
    s_cmp_eq_u32 s38, 0
    s_cselect_b32 s44, s14, s16
    s_cselect_b32 s45, s15, s17
    s_mov_b32 s32, s44
    s_and_b32 s33, s45, 0xffff
    s_mov_b32 s34, 1605632
    s_mov_b32 s35, 0x00020000
    s_lshl_b32 s41, s39, 6
    s_mov_b32 s42, 3584
    v_mul_u32_u24 v6, 14*3584, v4
    v_lshl_add_u32 v6, v3, 3, v6
    v_add_u32 v6, s41, v6
    s_lshl_b32 s43, s36, 7
    s_add_u32 s43, s43, 7299072
K0_CS_GO:
    s_mov_b32 s44, 0
    buffer_load_dwordx2 v[32:33], v6, s[32:35], s44 offen
    s_add_u32 s44, s44, s42
    buffer_load_dwordx2 v[34:35], v6, s[32:35], s44 offen
    s_add_u32 s44, s44, s42
    buffer_load_dwordx2 v[36:37], v6, s[32:35], s44 offen
    s_add_u32 s44, s44, s42
    buffer_load_dwordx2 v[38:39], v6, s[32:35], s44 offen
    s_add_u32 s44, s44, s42
    buffer_load_dwordx2 v[40:41], v6, s[32:35], s44 offen
    s_add_u32 s44, s44, s42
    buffer_load_dwordx2 v[42:43], v6, s[32:35], s44 offen
    s_add_u32 s44, s44, s42
    buffer_load_dwordx2 v[44:45], v6, s[32:35], s44 offen
    s_add_u32 s44, s44, s42
    buffer_load_dwordx2 v[46:47], v6, s[32:35], s44 offen
    s_add_u32 s44, s44, s42
    buffer_load_dwordx2 v[48:49], v6, s[32:35], s44 offen
    s_add_u32 s44, s44, s42
    buffer_load_dwordx2 v[50:51], v6, s[32:35], s44 offen
    s_add_u32 s44, s44, s42
    buffer_load_dwordx2 v[52:53], v6, s[32:35], s44 offen
    s_add_u32 s44, s44, s42
    buffer_load_dwordx2 v[54:55], v6, s[32:35], s44 offen
    s_add_u32 s44, s44, s42
    buffer_load_dwordx2 v[56:57], v6, s[32:35], s44 offen
    s_add_u32 s44, s44, s42
    buffer_load_dwordx2 v[58:59], v6, s[32:35], s44 offen
    s_add_u32 s44, s44, s42
    v_mov_b32 v8, 0
    v_mov_b32 v9, 0
    v_mov_b32 v10, 0
    v_mov_b32 v11, 0
    s_waitcnt vmcnt(13)
    v_lshlrev_b32 v12, 16, v32
    v_and_b32 v13, 0xffff0000, v32
    v_lshlrev_b32 v14, 16, v33
    v_and_b32 v15, 0xffff0000, v33
    v_pk_add_f32 v[8:9], v[8:9], v[12:13]
    v_pk_add_f32 v[10:11], v[10:11], v[14:15]
    s_waitcnt vmcnt(12)
    v_lshlrev_b32 v12, 16, v34
    v_and_b32 v13, 0xffff0000, v34
    v_lshlrev_b32 v14, 16, v35
    v_and_b32 v15, 0xffff0000, v35
    v_pk_add_f32 v[8:9], v[8:9], v[12:13]
    v_pk_add_f32 v[10:11], v[10:11], v[14:15]
    s_waitcnt vmcnt(11)
    v_lshlrev_b32 v12, 16, v36
    v_and_b32 v13, 0xffff0000, v36
    v_lshlrev_b32 v14, 16, v37
    v_and_b32 v15, 0xffff0000, v37
    v_pk_add_f32 v[8:9], v[8:9], v[12:13]
    v_pk_add_f32 v[10:11], v[10:11], v[14:15]
    s_waitcnt vmcnt(10)
    v_lshlrev_b32 v12, 16, v38
    v_and_b32 v13, 0xffff0000, v38
    v_lshlrev_b32 v14, 16, v39
    v_and_b32 v15, 0xffff0000, v39
    v_pk_add_f32 v[8:9], v[8:9], v[12:13]
    v_pk_add_f32 v[10:11], v[10:11], v[14:15]
    s_waitcnt vmcnt(9)
    v_lshlrev_b32 v12, 16, v40
    v_and_b32 v13, 0xffff0000, v40
    v_lshlrev_b32 v14, 16, v41
    v_and_b32 v15, 0xffff0000, v41
    v_pk_add_f32 v[8:9], v[8:9], v[12:13]
    v_pk_add_f32 v[10:11], v[10:11], v[14:15]
    s_waitcnt vmcnt(8)
    v_lshlrev_b32 v12, 16, v42
    v_and_b32 v13, 0xffff0000, v42
    v_lshlrev_b32 v14, 16, v43
    v_and_b32 v15, 0xffff0000, v43
    v_pk_add_f32 v[8:9], v[8:9], v[12:13]
    v_pk_add_f32 v[10:11], v[10:11], v[14:15]
    s_waitcnt vmcnt(7)
    v_lshlrev_b32 v12, 16, v44
    v_and_b32 v13, 0xffff0000, v44
    v_lshlrev_b32 v14, 16, v45
    v_and_b32 v15, 0xffff0000, v45
    v_pk_add_f32 v[8:9], v[8:9], v[12:13]
    v_pk_add_f32 v[10:11], v[10:11], v[14:15]
    s_waitcnt vmcnt(6)
    v_lshlrev_b32 v12, 16, v46
    v_and_b32 v13, 0xffff0000, v46
    v_lshlrev_b32 v14, 16, v47
    v_and_b32 v15, 0xffff0000, v47
    v_pk_add_f32 v[8:9], v[8:9], v[12:13]
    v_pk_add_f32 v[10:11], v[10:11], v[14:15]
    s_waitcnt vmcnt(5)
    v_lshlrev_b32 v12, 16, v48
    v_and_b32 v13, 0xffff0000, v48
    v_lshlrev_b32 v14, 16, v49
    v_and_b32 v15, 0xffff0000, v49
    v_pk_add_f32 v[8:9], v[8:9], v[12:13]
    v_pk_add_f32 v[10:11], v[10:11], v[14:15]
    s_waitcnt vmcnt(4)
    v_lshlrev_b32 v12, 16, v50
    v_and_b32 v13, 0xffff0000, v50
    v_lshlrev_b32 v14, 16, v51
    v_and_b32 v15, 0xffff0000, v51
    v_pk_add_f32 v[8:9], v[8:9], v[12:13]
    v_pk_add_f32 v[10:11], v[10:11], v[14:15]
    s_waitcnt vmcnt(3)
    v_lshlrev_b32 v12, 16, v52
    v_and_b32 v13, 0xffff0000, v52
    v_lshlrev_b32 v14, 16, v53
    v_and_b32 v15, 0xffff0000, v53
    v_pk_add_f32 v[8:9], v[8:9], v[12:13]
    v_pk_add_f32 v[10:11], v[10:11], v[14:15]
    s_waitcnt vmcnt(2)
    v_lshlrev_b32 v12, 16, v54
    v_and_b32 v13, 0xffff0000, v54
    v_lshlrev_b32 v14, 16, v55
    v_and_b32 v15, 0xffff0000, v55
    v_pk_add_f32 v[8:9], v[8:9], v[12:13]
    v_pk_add_f32 v[10:11], v[10:11], v[14:15]
    s_waitcnt vmcnt(1)
    v_lshlrev_b32 v12, 16, v56
    v_and_b32 v13, 0xffff0000, v56
    v_lshlrev_b32 v14, 16, v57
    v_and_b32 v15, 0xffff0000, v57
    v_pk_add_f32 v[8:9], v[8:9], v[12:13]
    v_pk_add_f32 v[10:11], v[10:11], v[14:15]
    s_waitcnt vmcnt(0)
    v_lshlrev_b32 v12, 16, v58
    v_and_b32 v13, 0xffff0000, v58
    v_lshlrev_b32 v14, 16, v59
    v_and_b32 v15, 0xffff0000, v59
    v_pk_add_f32 v[8:9], v[8:9], v[12:13]
    v_pk_add_f32 v[10:11], v[10:11], v[14:15]
    ds_swizzle_b32 v12, v8 offset:8223
    ds_swizzle_b32 v13, v9 offset:8223
    ds_swizzle_b32 v14, v10 offset:8223
    ds_swizzle_b32 v15, v11 offset:8223
    s_waitcnt lgkmcnt(0)
    v_add_f32 v8, v8, v12
    v_add_f32 v9, v9, v13
    v_add_f32 v10, v10, v14
    v_add_f32 v11, v11, v15
    ds_swizzle_b32 v12, v8 offset:16415
    ds_swizzle_b32 v13, v9 offset:16415
    ds_swizzle_b32 v14, v10 offset:16415
    ds_swizzle_b32 v15, v11 offset:16415
    s_waitcnt lgkmcnt(0)
    v_add_f32 v8, v8, v12
    v_add_f32 v9, v9, v13
    v_add_f32 v10, v10, v14
    v_add_f32 v11, v11, v15
    v_mov_b32 v12, v8
    v_mov_b32 v13, v9
    v_mov_b32 v14, v10
    v_mov_b32 v15, v11
    s_nop 1
    v_permlane32_swap_b32 v8, v12
    v_permlane32_swap_b32 v9, v13
    v_permlane32_swap_b32 v10, v14
    v_permlane32_swap_b32 v11, v15
    s_nop 1
    v_add_f32 v8, v8, v12
    v_add_f32 v9, v9, v13
    v_add_f32 v10, v10, v14
    v_add_f32 v11, v11, v15
    v_lshlrev_b32 v6, 4, v3
    s_lshl_b32 s37, s3, 7
    v_add_u32 v7, s37, v6
    ds_write_b128 v7, v[8:11]
    s_waitcnt lgkmcnt(0)
    s_barrier
    s_cmp_lg_u32 s3, 0
    s_cbranch_scc1 K0_END
    ds_read_b128 v[12:15], v6 offset:128
    ds_read_b128 v[16:19], v6 offset:256
    ds_read_b128 v[20:23], v6 offset:384
    s_waitcnt lgkmcnt(0)
    v_add_f32 v8, v8, v12
    v_add_f32 v9, v9, v13
    v_add_f32 v10, v10, v14
    v_add_f32 v11, v11, v15
    v_add_f32 v8, v8, v16
    v_add_f32 v9, v9, v17
    v_add_f32 v10, v10, v18
    v_add_f32 v11, v11, v19
    v_add_f32 v8, v8, v20
    v_add_f32 v9, v9, v21
    v_add_f32 v10, v10, v22
    v_add_f32 v11, v11, v23
    buffer_store_dwordx4 v[8:11], v6, s[28:31], s43 offen
K0_END:
    s_endpgm
.globl mega_kernel
.p2align 8
.type mega_kernel,@function
mega_kernel:
    s_cmp_ge_u32 s2, 256
    s_cbranch_scc1 M_END
    s_load_dwordx16 s[4:19], s[0:1], 0
    s_load_dwordx4 s[20:23], s[0:1], 64
    s_load_dwordx2 s[24:25], s[0:1], 80
    s_waitcnt lgkmcnt(0)
    s_mov_b32 s28, s24
    s_and_b32 s29, s25, 0xffff
    s_mov_b32 s30, 268435456
    s_mov_b32 s31, 0x00020000
    s_mov_b32 s36, s20
    s_and_b32 s37, s21, 0xffff
    s_mov_b32 s38, 1835008
    s_mov_b32 s39, 0x00020000
    v_lshrrev_b32 v1, 6, v0
    v_and_b32 v2, 63, v0
    s_nop 0
    v_readfirstlane_b32 s52, v1
    v_lshlrev_b32 v1, 4, v2
    v_and_b32 v10, 31, v2
    v_lshrrev_b32 v11, 5, v2
    s_mov_b32 s60, 0
    s_mov_b32 s61, -1
    s_and_b32 s75, s52, 3
    s_lshr_b32 s76, s52, 2
    s_and_b32 s46, s2, 7
    s_lshr_b32 s47, s2, 3
    s_and_b32 s50, s46, 1
    s_lshl_b32 s50, s50, 3
    s_and_b32 s51, s47, 7
    s_add_u32 s50, s50, s51
    s_lshr_b32 s51, s46, 1
    s_lshl_b32 s51, s51, 2
    s_lshr_b32 s49, s47, 3
    s_add_u32 s51, s51, s49
    s_mov_b32 s49, 0x24924925
    s_mul_hi_u32 s71, s47, s49
    s_mul_i32 s70, s71, 7
    s_sub_u32 s70, s47, s70
    s_lshr_b32 s49, s46, 1
    s_lshl_b32 s49, s49, 2
    s_add_u32 s73, s71, s49
    s_and_b32 s49, s46, 1
    s_mul_i32 s49, s49, 7
    s_add_u32 s72, s70, s49
    s_lshl_b32 s49, s46, 2
    s_add_u32 s71, s71, s49
    s_getreg_b32 s74, hwreg(HW_REG_XCC_ID, 0, 4)
    s_lshl_b32 s74, s74, 14
    s_add_u32 s74, s74, 16384
    s_mov_b32 s48, 0
    s_mul_i32 s57, s50, 384
    s_lshl_b32 s58, s76, 7
    s_add_u32 s58, s57, s58
    s_add_u32 s58, s58, 7290880
    s_add_u32 s57, s57, 7291136
    v_lshlrev_b32 v5, 4, v11
    buffer_load_dwordx4 v[64:67], v5, s[28:31], s58 offen offset:0
    buffer_load_dwordx4 v[68:71], v5, s[28:31], s58 offen offset:32
    buffer_load_dwordx4 v[72:75], v5, s[28:31], s58 offen offset:64
    buffer_load_dwordx4 v[76:79], v5, s[28:31], s58 offen offset:96
    buffer_load_dwordx4 v[80:83], v5, s[28:31], s57 offen offset:0
    buffer_load_dwordx4 v[84:87], v5, s[28:31], s57 offen offset:32
    buffer_load_dwordx4 v[88:91], v5, s[28:31], s57 offen offset:64
    buffer_load_dwordx4 v[92:95], v5, s[28:31], s57 offen offset:96
    s_lshl_b32 s57, s50, 11
    s_add_u32 s57, s57, 1376256
    buffer_load_dwordx4 a[64:67], v1, s[28:31], s57 offen
    buffer_load_dwordx4 a[68:71], v1, s[28:31], s57 offen offset:1024
M_LOOP:
    s_mul_i32 s80, s48, 3670016
    s_add_u32 s80, s80, 15704064
    s_add_u32 s81, s80, 1835008
    s_add_u32 s82, s80, 3670016
    s_mul_i32 s83, s48, 4194304
    s_add_u32 s83, s83, 7315456
    s_mul_i32 s84, s48, 7340032
    s_add_u32 s84, s84, 23044096
    s_lshl_b32 s85, s48, 17
    s_add_u32 s85, s85, 6684672
    s_lshl_b32 s87, s48, 15
    s_sub_u32 s86, 6995968, s87
    s_add_u32 s87, s87, 6946816
    s_mov_b32 s88, 6963200
    s_lshl_b32 s89, s48, 11
    s_add_u32 s90, s89, 7016448
    s_add_u32 s91, s89, 7020544
    s_add_u32 s89, s89, 7012352
    s_cmp_eq_u32 s48, 0
    s_cbranch_scc1 P1_NOWAIT
    s_cmp_lg_u32 s52, 0
    s_cbranch_scc1 WT0_P
    s_lshl_b32 s57, s51, 7
    s_add_u32 s57, s57, 7024640
    v_lshlrev_b32 v9, 7, v2
    s_mov_b64 exec, 1
    s_mov_b32 s58, 0
WT0_L:
    buffer_load_dword v3, v9, s[28:31], s57 offen sc1
    s_waitcnt vmcnt(0)
    v_cmp_gt_u32 vcc, 14, v3
    s_add_u32 s58, s58, 1
    s_cmp_eq_u64 vcc, 0
    s_cbranch_scc1 WT0_E
    s_sleep 1
    s_cmp_lt_u32 s58, 0x40000
    s_cbranch_scc1 WT0_L
WT0_E:
    s_mov_b64 exec, -1
    s_barrier
    s_branch WT0_D
WT0_P:
    s_barrier
WT0_D:
P1_NOWAIT:
    s_mul_i32 s55, s50, 84*1024
    s_add_u32 s55, s55, 0
    s_mul_i32 s56, s52, 10
    s_min_u32 s57, s52, 4
    s_add_u32 s56, s56, s57
    s_lshl_b32 s56, s56, 10
    s_add_u32 s55, s55, s56
    s_add_u32 m0, s56, 0
    s_add_u32 s57, s55, 0
    buffer_load_dwordx4 v1, s[28:31], s57 offen offset:0 lds
    buffer_load_dwordx4 v1, s[28:31], s57 offen offset:1024 lds
    buffer_load_dwordx4 v1, s[28:31], s57 offen offset:2048 lds
    buffer_load_dwordx4 v1, s[28:31], s57 offen offset:3072 lds
    s_add_u32 m0, s56, 4096
    s_add_u32 s57, s55, 4096
    buffer_load_dwordx4 v1, s[28:31], s57 offen offset:0 lds
    buffer_load_dwordx4 v1, s[28:31], s57 offen offset:1024 lds
    buffer_load_dwordx4 v1, s[28:31], s57 offen offset:2048 lds
    buffer_load_dwordx4 v1, s[28:31], s57 offen offset:3072 lds
    s_add_u32 m0, s56, 8192
    s_add_u32 s57, s55, 8192
    buffer_load_dwordx4 v1, s[28:31], s57 offen offset:0 lds
    buffer_load_dwordx4 v1, s[28:31], s57 offen offset:1024 lds
    s_cmp_ge_u32 s52, 4
    s_cbranch_scc1 WD1
    buffer_load_dwordx4 v1, s[28:31], s57 offen offset:2048 lds
WD1:
    s_lshl_b32 s53, s51, 2
    s_add_u32 s53, s53, s75
    s_lshl_b32 s57, s53, 8
    s_add_u32 s57, s57, s86
    v_lshlrev_b32 v4, 3, v10
    buffer_load_dwordx2 v[96:97], v4, s[28:31], s57 offen
    s_mul_i32 s64, s53, 28672
    s_add_u32 s64, s64, s80
    s_add_u32 s57, s64, 0
    buffer_load_dwordx4 a[0:3], v1, s[28:31], s57 offen offset:0
    s_add_u32 s57, s64, 0
    buffer_load_dwordx4 a[4:7], v1, s[28:31], s57 offen offset:1024
    s_add_u32 s57, s64, 0
    buffer_load_dwordx4 a[8:11], v1, s[28:31], s57 offen offset:2048
    s_add_u32 s57, s64, 0
    buffer_load_dwordx4 a[12:15], v1, s[28:31], s57 offen offset:3072
    s_add_u32 s57, s64, 4096
    buffer_load_dwordx4 a[16:19], v1, s[28:31], s57 offen offset:0
    s_add_u32 s57, s64, 4096
    buffer_load_dwordx4 a[20:23], v1, s[28:31], s57 offen offset:1024
    s_add_u32 s57, s64, 4096
    buffer_load_dwordx4 a[24:27], v1, s[28:31], s57 offen offset:2048
    s_add_u32 s57, s64, 4096
    buffer_load_dwordx4 a[28:31], v1, s[28:31], s57 offen offset:3072
    s_add_u32 s57, s64, 8192
    buffer_load_dwordx4 a[32:35], v1, s[28:31], s57 offen offset:0
    s_add_u32 s57, s64, 8192
    buffer_load_dwordx4 a[36:39], v1, s[28:31], s57 offen offset:1024
    s_add_u32 s57, s64, 8192
    buffer_load_dwordx4 a[40:43], v1, s[28:31], s57 offen offset:2048
    s_add_u32 s57, s64, 8192
    buffer_load_dwordx4 a[44:47], v1, s[28:31], s57 offen offset:3072
    s_add_u32 s57, s64, 12288
    buffer_load_dwordx4 a[48:51], v1, s[28:31], s57 offen offset:0
    s_add_u32 s57, s64, 12288
    buffer_load_dwordx4 a[52:55], v1, s[28:31], s57 offen offset:1024
    s_add_u32 s57, s64, 12288
    buffer_load_dwordx4 a[56:59], v1, s[28:31], s57 offen offset:2048
    s_add_u32 s57, s64, 12288
    buffer_load_dwordx4 a[60:63], v1, s[28:31], s57 offen offset:3072
    v_add_u32 v6, 57344, v1
    s_waitcnt vmcnt(16)
    s_barrier
    s_lshl_b32 s59, s75, 13
    s_add_u32 s59, s59, 86016
    s_cmp_lg_u32 s76, 0
    s_cbranch_scc1 P1KV2
    ds_read_b128 v[16:19], v1 offset:0
    ds_read_b128 v[20:23], v6 offset:0
    ds_read_b128 v[24:27], v1 offset:1024
    ds_read_b128 v[28:31], v6 offset:1024
    s_waitcnt vmcnt(15) lgkmcnt(2)
    v_mfma_f32_32x32x16_bf16 v[32:47], v[16:19], a[0:3], 0
    v_mfma_f32_32x32x16_bf16 v[48:63], v[20:23], a[0:3], 0
    s_add_u32 s57, s64, 16384
    buffer_load_dwordx4 a[0:3], v1, s[28:31], s57 offen offset:0
    ds_read_b128 v[16:19], v1 offset:2048
    ds_read_b128 v[20:23], v6 offset:2048
    s_waitcnt vmcnt(15) lgkmcnt(2)
    v_mfma_f32_32x32x16_bf16 v[32:47], v[24:27], a[4:7], v[32:47]
    v_mfma_f32_32x32x16_bf16 v[48:63], v[28:31], a[4:7], v[48:63]
    s_add_u32 s57, s64, 16384
    buffer_load_dwordx4 a[4:7], v1, s[28:31], s57 offen offset:1024
    ds_read_b128 v[24:27], v1 offset:3072
    ds_read_b128 v[28:31], v6 offset:3072
    s_waitcnt vmcnt(15) lgkmcnt(2)
    v_mfma_f32_32x32x16_bf16 v[32:47], v[16:19], a[8:11], v[32:47]
    v_mfma_f32_32x32x16_bf16 v[48:63], v[20:23], a[8:11], v[48:63]
    s_add_u32 s57, s64, 16384
    buffer_load_dwordx4 a[8:11], v1, s[28:31], s57 offen offset:2048
    ds_read_b128 v[16:19], v1 offset:4096
    ds_read_b128 v[20:23], v6 offset:4096
    s_waitcnt vmcnt(15) lgkmcnt(2)
    v_mfma_f32_32x32x16_bf16 v[32:47], v[24:27], a[12:15], v[32:47]
    v_mfma_f32_32x32x16_bf16 v[48:63], v[28:31], a[12:15], v[48:63]
    s_add_u32 s57, s64, 16384
    buffer_load_dwordx4 a[12:15], v1, s[28:31], s57 offen offset:3072
    ds_read_b128 v[24:27], v1 offset:5120
    ds_read_b128 v[28:31], v6 offset:5120
    s_waitcnt vmcnt(15) lgkmcnt(2)
    v_mfma_f32_32x32x16_bf16 v[32:47], v[16:19], a[16:19], v[32:47]
    v_mfma_f32_32x32x16_bf16 v[48:63], v[20:23], a[16:19], v[48:63]
    s_add_u32 s57, s64, 20480
    buffer_load_dwordx4 a[16:19], v1, s[28:31], s57 offen offset:0
    ds_read_b128 v[16:19], v1 offset:6144
    ds_read_b128 v[20:23], v6 offset:6144
    s_waitcnt vmcnt(15) lgkmcnt(2)
    v_mfma_f32_32x32x16_bf16 v[32:47], v[24:27], a[20:23], v[32:47]
    v_mfma_f32_32x32x16_bf16 v[48:63], v[28:31], a[20:23], v[48:63]
    s_add_u32 s57, s64, 20480
    buffer_load_dwordx4 a[20:23], v1, s[28:31], s57 offen offset:1024
    ds_read_b128 v[24:27], v1 offset:7168
    ds_read_b128 v[28:31], v6 offset:7168
    s_waitcnt vmcnt(15) lgkmcnt(2)
    v_mfma_f32_32x32x16_bf16 v[32:47], v[16:19], a[24:27], v[32:47]
    v_mfma_f32_32x32x16_bf16 v[48:63], v[20:23], a[24:27], v[48:63]
    s_add_u32 s57, s64, 20480
    buffer_load_dwordx4 a[24:27], v1, s[28:31], s57 offen offset:2048
    ds_read_b128 v[16:19], v1 offset:8192
    ds_read_b128 v[20:23], v6 offset:8192
    s_waitcnt vmcnt(15) lgkmcnt(2)
    v_mfma_f32_32x32x16_bf16 v[32:47], v[24:27], a[28:31], v[32:47]
    v_mfma_f32_32x32x16_bf16 v[48:63], v[28:31], a[28:31], v[48:63]
    s_add_u32 s57, s64, 20480
    buffer_load_dwordx4 a[28:31], v1, s[28:31], s57 offen offset:3072
    ds_read_b128 v[24:27], v1 offset:9216
    ds_read_b128 v[28:31], v6 offset:9216
    s_waitcnt vmcnt(15) lgkmcnt(2)
    v_mfma_f32_32x32x16_bf16 v[32:47], v[16:19], a[32:35], v[32:47]
    v_mfma_f32_32x32x16_bf16 v[48:63], v[20:23], a[32:35], v[48:63]
    s_add_u32 s57, s64, 24576
    buffer_load_dwordx4 a[32:35], v1, s[28:31], s57 offen offset:0
    ds_read_b128 v[16:19], v1 offset:10240
    ds_read_b128 v[20:23], v6 offset:10240
    s_waitcnt vmcnt(15) lgkmcnt(2)
    v_mfma_f32_32x32x16_bf16 v[32:47], v[24:27], a[36:39], v[32:47]
    v_mfma_f32_32x32x16_bf16 v[48:63], v[28:31], a[36:39], v[48:63]
    s_add_u32 s57, s64, 24576
    buffer_load_dwordx4 a[36:39], v1, s[28:31], s57 offen offset:1024
    ds_read_b128 v[24:27], v1 offset:11264
    ds_read_b128 v[28:31], v6 offset:11264
    s_waitcnt vmcnt(15) lgkmcnt(2)
    v_mfma_f32_32x32x16_bf16 v[32:47], v[16:19], a[40:43], v[32:47]
    v_mfma_f32_32x32x16_bf16 v[48:63], v[20:23], a[40:43], v[48:63]
    s_add_u32 s57, s64, 24576
    buffer_load_dwordx4 a[40:43], v1, s[28:31], s57 offen offset:2048
    ds_read_b128 v[16:19], v1 offset:12288
    ds_read_b128 v[20:23], v6 offset:12288
    s_waitcnt vmcnt(15) lgkmcnt(2)
    v_mfma_f32_32x32x16_bf16 v[32:47], v[24:27], a[44:47], v[32:47]
    v_mfma_f32_32x32x16_bf16 v[48:63], v[28:31], a[44:47], v[48:63]
    s_add_u32 s57, s64, 24576
    buffer_load_dwordx4 a[44:47], v1, s[28:31], s57 offen offset:3072
    ds_read_b128 v[24:27], v1 offset:13312
    ds_read_b128 v[28:31], v6 offset:13312
    s_waitcnt vmcnt(15) lgkmcnt(2)
    v_mfma_f32_32x32x16_bf16 v[32:47], v[16:19], a[48:51], v[32:47]
    v_mfma_f32_32x32x16_bf16 v[48:63], v[20:23], a[48:51], v[48:63]
    ds_read_b128 v[16:19], v1 offset:14336
    ds_read_b128 v[20:23], v6 offset:14336
    s_waitcnt vmcnt(14) lgkmcnt(2)
    v_mfma_f32_32x32x16_bf16 v[32:47], v[24:27], a[52:55], v[32:47]
    v_mfma_f32_32x32x16_bf16 v[48:63], v[28:31], a[52:55], v[48:63]
    ds_read_b128 v[24:27], v1 offset:15360
    ds_read_b128 v[28:31], v6 offset:15360
    s_waitcnt vmcnt(13) lgkmcnt(2)
    v_mfma_f32_32x32x16_bf16 v[32:47], v[16:19], a[56:59], v[32:47]
    v_mfma_f32_32x32x16_bf16 v[48:63], v[20:23], a[56:59], v[48:63]
    ds_read_b128 v[16:19], v1 offset:16384
    ds_read_b128 v[20:23], v6 offset:16384
    s_waitcnt vmcnt(12) lgkmcnt(2)
    v_mfma_f32_32x32x16_bf16 v[32:47], v[24:27], a[60:63], v[32:47]
    v_mfma_f32_32x32x16_bf16 v[48:63], v[28:31], a[60:63], v[48:63]
    ds_read_b128 v[24:27], v1 offset:17408
    ds_read_b128 v[28:31], v6 offset:17408
    s_waitcnt vmcnt(11) lgkmcnt(2)
    v_mfma_f32_32x32x16_bf16 v[32:47], v[16:19], a[0:3], v[32:47]
    v_mfma_f32_32x32x16_bf16 v[48:63], v[20:23], a[0:3], v[48:63]
    ds_read_b128 v[16:19], v1 offset:18432
    ds_read_b128 v[20:23], v6 offset:18432
    s_waitcnt vmcnt(10) lgkmcnt(2)
    v_mfma_f32_32x32x16_bf16 v[32:47], v[24:27], a[4:7], v[32:47]
    v_mfma_f32_32x32x16_bf16 v[48:63], v[28:31], a[4:7], v[48:63]
    ds_read_b128 v[24:27], v1 offset:19456
    ds_read_b128 v[28:31], v6 offset:19456
    s_waitcnt vmcnt(9) lgkmcnt(2)
    v_mfma_f32_32x32x16_bf16 v[32:47], v[16:19], a[8:11], v[32:47]
    v_mfma_f32_32x32x16_bf16 v[48:63], v[20:23], a[8:11], v[48:63]
    ds_read_b128 v[16:19], v1 offset:20480
    ds_read_b128 v[20:23], v6 offset:20480
    s_waitcnt vmcnt(8) lgkmcnt(2)
    v_mfma_f32_32x32x16_bf16 v[32:47], v[24:27], a[12:15], v[32:47]
    v_mfma_f32_32x32x16_bf16 v[48:63], v[28:31], a[12:15], v[48:63]
    ds_read_b128 v[24:27], v1 offset:21504
    ds_read_b128 v[28:31], v6 offset:21504
    s_waitcnt vmcnt(7) lgkmcnt(2)
    v_mfma_f32_32x32x16_bf16 v[32:47], v[16:19], a[16:19], v[32:47]
    v_mfma_f32_32x32x16_bf16 v[48:63], v[20:23], a[16:19], v[48:63]
    ds_read_b128 v[16:19], v1 offset:22528
    ds_read_b128 v[20:23], v6 offset:22528
    s_waitcnt vmcnt(6) lgkmcnt(2)
    v_mfma_f32_32x32x16_bf16 v[32:47], v[24:27], a[20:23], v[32:47]
    v_mfma_f32_32x32x16_bf16 v[48:63], v[28:31], a[20:23], v[48:63]
    ds_read_b128 v[24:27], v1 offset:23552
    ds_read_b128 v[28:31], v6 offset:23552
    s_waitcnt vmcnt(5) lgkmcnt(2)
    v_mfma_f32_32x32x16_bf16 v[32:47], v[16:19], a[24:27], v[32:47]
    v_mfma_f32_32x32x16_bf16 v[48:63], v[20:23], a[24:27], v[48:63]
    ds_read_b128 v[16:19], v1 offset:24576
    ds_read_b128 v[20:23], v6 offset:24576
    s_waitcnt vmcnt(4) lgkmcnt(2)
    v_mfma_f32_32x32x16_bf16 v[32:47], v[24:27], a[28:31], v[32:47]
    v_mfma_f32_32x32x16_bf16 v[48:63], v[28:31], a[28:31], v[48:63]
    ds_read_b128 v[24:27], v1 offset:25600
    ds_read_b128 v[28:31], v6 offset:25600
    s_waitcnt vmcnt(3) lgkmcnt(2)
    v_mfma_f32_32x32x16_bf16 v[32:47], v[16:19], a[32:35], v[32:47]
    v_mfma_f32_32x32x16_bf16 v[48:63], v[20:23], a[32:35], v[48:63]
    ds_read_b128 v[16:19], v1 offset:26624
    ds_read_b128 v[20:23], v6 offset:26624
    s_waitcnt vmcnt(2) lgkmcnt(2)
    v_mfma_f32_32x32x16_bf16 v[32:47], v[24:27], a[36:39], v[32:47]
    v_mfma_f32_32x32x16_bf16 v[48:63], v[28:31], a[36:39], v[48:63]
    ds_read_b128 v[24:27], v1 offset:27648
    ds_read_b128 v[28:31], v6 offset:27648
    s_waitcnt vmcnt(1) lgkmcnt(2)
    v_mfma_f32_32x32x16_bf16 v[32:47], v[16:19], a[40:43], v[32:47]
    v_mfma_f32_32x32x16_bf16 v[48:63], v[20:23], a[40:43], v[48:63]
    s_waitcnt vmcnt(0) lgkmcnt(0)
    v_mfma_f32_32x32x16_bf16 v[32:47], v[24:27], a[44:47], v[32:47]
    v_mfma_f32_32x32x16_bf16 v[48:63], v[28:31], a[44:47], v[48:63]
    v_mul_f32 v96, 0x3b124925, v96
    v_mul_f32 v97, 0x3b124925, v97
    v_fma_f32 v97, -v96, v96, v97
    v_max_f32 v97, 0, v97
    v_cvt_pk_bf16_f32 v98, v97, v96
    v_lshlrev_b32 v99, 16, v98
    v_and_b32 v98, 0xffff0000, v98
    v_add_f32 v99, 0x3727c5ac, v99
    v_cvt_pk_bf16_f32 v99, v99, v99
    v_lshlrev_b32 v99, 16, v99
    v_sqrt_f32 v99, v99
    s_nop 0
    v_cvt_pk_bf16_f32 v99, v99, v99
    v_lshlrev_b32 v99, 16, v99
    v_rcp_f32 v96, v99
    s_nop 0
    v_mul_f32 v97, v98, v96
    v_sub_f32 v97, 0, v97
    s_nop 3
    v_pk_mul_f32 v[98:99], v[80:81], v[96:97] op_sel:[0,1] op_sel_hi:[1,1]
    v_pk_fma_f32 v[48:49], v[48:49], v[96:97], v[98:99] op_sel_hi:[1,0,1]
    v_pk_mul_f32 v[98:99], v[82:83], v[96:97] op_sel:[0,1] op_sel_hi:[1,1]
    v_pk_fma_f32 v[50:51], v[50:51], v[96:97], v[98:99] op_sel_hi:[1,0,1]
    v_pk_mul_f32 v[98:99], v[84:85], v[96:97] op_sel:[0,1] op_sel_hi:[1,1]
    v_pk_fma_f32 v[52:53], v[52:53], v[96:97], v[98:99] op_sel_hi:[1,0,1]
    v_pk_mul_f32 v[98:99], v[86:87], v[96:97] op_sel:[0,1] op_sel_hi:[1,1]
    v_pk_fma_f32 v[54:55], v[54:55], v[96:97], v[98:99] op_sel_hi:[1,0,1]
    v_pk_mul_f32 v[98:99], v[88:89], v[96:97] op_sel:[0,1] op_sel_hi:[1,1]
    v_pk_fma_f32 v[56:57], v[56:57], v[96:97], v[98:99] op_sel_hi:[1,0,1]
    v_pk_mul_f32 v[98:99], v[90:91], v[96:97] op_sel:[0,1] op_sel_hi:[1,1]
    v_pk_fma_f32 v[58:59], v[58:59], v[96:97], v[98:99] op_sel_hi:[1,0,1]
    v_pk_mul_f32 v[98:99], v[92:93], v[96:97] op_sel:[0,1] op_sel_hi:[1,1]
    v_pk_fma_f32 v[60:61], v[60:61], v[96:97], v[98:99] op_sel_hi:[1,0,1]
    v_pk_mul_f32 v[98:99], v[94:95], v[96:97] op_sel:[0,1] op_sel_hi:[1,1]
    v_pk_fma_f32 v[62:63], v[62:63], v[96:97], v[98:99] op_sel_hi:[1,0,1]
    v_cvt_pk_bf16_f32 v80, v48, v49
    v_cvt_pk_bf16_f32 v81, v50, v51
    v_cvt_pk_bf16_f32 v82, v52, v53
    v_cvt_pk_bf16_f32 v83, v54, v55
    v_cvt_pk_bf16_f32 v84, v56, v57
    v_cvt_pk_bf16_f32 v85, v58, v59
    v_cvt_pk_bf16_f32 v86, v60, v61
    v_cvt_pk_bf16_f32 v87, v62, v63
    v_mov_b32 v12, 0x00003f80
    v_cndmask_b32 v86, v86, v12, s[60:61]
    v_mul_u32_u24 v12, 72, v10
    v_lshl_add_u32 v12, v11, 3, v12
    v_add_u32 v12, s59, v12
    ds_write_b64 v12, v[80:81] offset:4352
    ds_write_b64 v12, v[82:83] offset:4368
    ds_write_b64 v12, v[84:85] offset:4384
    ds_write_b64 v12, v[86:87] offset:4400
    v_pk_mul_f32 v[98:99], v[64:65], v[96:97] op_sel:[0,1] op_sel_hi:[1,1]
    v_pk_fma_f32 v[32:33], v[32:33], v[96:97], v[98:99] op_sel_hi:[1,0,1]
    v_pk_mul_f32 v[98:99], v[66:67], v[96:97] op_sel:[0,1] op_sel_hi:[1,1]
    v_pk_fma_f32 v[34:35], v[34:35], v[96:97], v[98:99] op_sel_hi:[1,0,1]
    v_pk_mul_f32 v[98:99], v[68:69], v[96:97] op_sel:[0,1] op_sel_hi:[1,1]
    v_pk_fma_f32 v[36:37], v[36:37], v[96:97], v[98:99] op_sel_hi:[1,0,1]
    v_pk_mul_f32 v[98:99], v[70:71], v[96:97] op_sel:[0,1] op_sel_hi:[1,1]
    v_pk_fma_f32 v[38:39], v[38:39], v[96:97], v[98:99] op_sel_hi:[1,0,1]
    v_pk_mul_f32 v[98:99], v[72:73], v[96:97] op_sel:[0,1] op_sel_hi:[1,1]
    v_pk_fma_f32 v[40:41], v[40:41], v[96:97], v[98:99] op_sel_hi:[1,0,1]
    v_pk_mul_f32 v[98:99], v[74:75], v[96:97] op_sel:[0,1] op_sel_hi:[1,1]
    v_pk_fma_f32 v[42:43], v[42:43], v[96:97], v[98:99] op_sel_hi:[1,0,1]
    v_pk_mul_f32 v[98:99], v[76:77], v[96:97] op_sel:[0,1] op_sel_hi:[1,1]
    v_pk_fma_f32 v[44:45], v[44:45], v[96:97], v[98:99] op_sel_hi:[1,0,1]
    v_pk_mul_f32 v[98:99], v[78:79], v[96:97] op_sel:[0,1] op_sel_hi:[1,1]
    v_pk_fma_f32 v[46:47], v[46:47], v[96:97], v[98:99] op_sel_hi:[1,0,1]
    v_cvt_pk_bf16_f32 v16, v32, v33
    v_cvt_pk_bf16_f32 v17, v34, v35
    v_cvt_pk_bf16_f32 v18, v36, v37
    v_cvt_pk_bf16_f32 v19, v38, v39
    v_cvt_pk_bf16_f32 v20, v40, v41
    v_cvt_pk_bf16_f32 v21, v42, v43
    v_cvt_pk_bf16_f32 v22, v44, v45
    v_cvt_pk_bf16_f32 v23, v46, v47
    s_nop 1
    v_mfma_f32_32x32x16_bf16 v[32:47], a[64:67], v[16:19], 0
    v_mfma_f32_32x32x16_bf16 v[32:47], a[68:71], v[20:23], v[32:47]
    s_waitcnt lgkmcnt(0)
    s_barrier
    s_nop 11
    v_cvt_pk_bf16_f32 v16, v32, v33
    v_cvt_pk_bf16_f32 v17, v34, v35
    v_cvt_pk_bf16_f32 v18, v36, v37
    v_cvt_pk_bf16_f32 v19, v38, v39
    v_cvt_pk_bf16_f32 v20, v40, v41
    v_cvt_pk_bf16_f32 v21, v42, v43
    v_cvt_pk_bf16_f32 v22, v44, v45
    v_cvt_pk_bf16_f32 v23, v46, v47
    v_lshlrev_b32 v100, 16, v16
    v_and_b32 v101, 0xffff0000, v16
    v_lshlrev_b32 v102, 16, v17
    v_and_b32 v103, 0xffff0000, v17
    v_lshlrev_b32 v104, 16, v18
    v_and_b32 v105, 0xffff0000, v18
    v_lshlrev_b32 v106, 16, v19
    v_and_b32 v107, 0xffff0000, v19
    v_lshlrev_b32 v108, 16, v20
    v_and_b32 v109, 0xffff0000, v20
    v_lshlrev_b32 v110, 16, v21
    v_and_b32 v111, 0xffff0000, v21
    v_lshlrev_b32 v112, 16, v22
    v_and_b32 v113, 0xffff0000, v22
    v_lshlrev_b32 v114, 16, v23
    v_and_b32 v115, 0xffff0000, v23
    v_cndmask_b32 v112, v112, v100, s[60:61]
    v_cndmask_b32 v113, v113, v100, s[60:61]
    v_cndmask_b32 v114, v114, v100, s[60:61]
    v_cndmask_b32 v115, v115, v100, s[60:61]
    v_max3_f32 v148, v100, v101, v102
    v_min3_f32 v149, v100, v101, v102
    v_max3_f32 v148, v148, v103, v104
    v_min3_f32 v149, v149, v103, v104
    v_max3_f32 v148, v148, v105, v106
    v_min3_f32 v149, v149, v105, v106
    v_max3_f32 v148, v148, v107, v108
    v_min3_f32 v149, v149, v107, v108
    v_max3_f32 v148, v148, v109, v110
    v_min3_f32 v149, v149, v109, v110
    v_max3_f32 v148, v148, v111, v112
    v_min3_f32 v149, v149, v111, v112
    v_max3_f32 v148, v148, v113, v114
    v_min3_f32 v149, v149, v113, v114
    v_max_f32 v148, v148, v115
    v_min_f32 v149, v149, v115
    v_mov_b32 v150, v148
    v_mov_b32 v151, v149
    s_nop 1
    v_permlane32_swap_b32 v148, v150
    v_permlane32_swap_b32 v149, v151
    s_nop 1
    v_max_f32 v148, v148, v150
    v_min_f32 v149, v149, v151
    v_mul_f32 v148, 0xbfb8aa3b, v148
    v_mul_f32 v149, 0x3fb8aa3b, v149
    v_mov_b32 v152, 0x3fb8aa3b
    v_fma_f32 v116, v100, v152, v148
    v_fma_f32 v132, -v100, v152, v149
    v_fma_f32 v117, v101, v152, v148
    v_fma_f32 v133, -v101, v152, v149
    v_fma_f32 v118, v102, v152, v148
    v_fma_f32 v134, -v102, v152, v149
    v_fma_f32 v119, v103, v152, v148
    v_fma_f32 v135, -v103, v152, v149
    v_fma_f32 v120, v104, v152, v148
    v_fma_f32 v136, -v104, v152, v149
    v_fma_f32 v121, v105, v152, v148
    v_fma_f32 v137, -v105, v152, v149
    v_fma_f32 v122, v106, v152, v148
    v_fma_f32 v138, -v106, v152, v149
    v_fma_f32 v123, v107, v152, v148
    v_fma_f32 v139, -v107, v152, v149
    v_fma_f32 v124, v108, v152, v148
    v_fma_f32 v140, -v108, v152, v149
    v_fma_f32 v125, v109, v152, v148
    v_fma_f32 v141, -v109, v152, v149
    v_fma_f32 v126, v110, v152, v148
    v_fma_f32 v142, -v110, v152, v149
    v_fma_f32 v127, v111, v152, v148
    v_fma_f32 v143, -v111, v152, v149
    v_fma_f32 v128, v112, v152, v148
    v_fma_f32 v144, -v112, v152, v149
    v_fma_f32 v129, v113, v152, v148
    v_fma_f32 v145, -v113, v152, v149
    v_fma_f32 v130, v114, v152, v148
    v_fma_f32 v146, -v114, v152, v149
    v_fma_f32 v131, v115, v152, v148
    v_fma_f32 v147, -v115, v152, v149
    v_exp_f32 v116, v116
    v_exp_f32 v117, v117
    v_exp_f32 v118, v118
    v_exp_f32 v119, v119
    v_exp_f32 v120, v120
    v_exp_f32 v121, v121
    v_exp_f32 v122, v122
    v_exp_f32 v123, v123
    v_exp_f32 v124, v124
    v_exp_f32 v125, v125
    v_exp_f32 v126, v126
    v_exp_f32 v127, v127
    v_exp_f32 v128, v128
    v_exp_f32 v129, v129
    v_exp_f32 v130, v130
    v_exp_f32 v131, v131
    v_exp_f32 v132, v132
    v_exp_f32 v133, v133
    v_exp_f32 v134, v134
    v_exp_f32 v135, v135
    v_exp_f32 v136, v136
    v_exp_f32 v137, v137
    v_exp_f32 v138, v138
    v_exp_f32 v139, v139
    v_exp_f32 v140, v140
    v_exp_f32 v141, v141
    v_exp_f32 v142, v142
    v_exp_f32 v143, v143
    v_exp_f32 v144, v144
    v_exp_f32 v145, v145
    v_exp_f32 v146, v146
    v_exp_f32 v147, v147
    s_nop 0
    v_cndmask_b32 v128, v128, 0, s[60:61]
    v_cndmask_b32 v144, v144, 0, s[60:61]
    v_cndmask_b32 v129, v129, 0, s[60:61]
    v_cndmask_b32 v145, v145, 0, s[60:61]
    v_cndmask_b32 v130, v130, 0, s[60:61]
    v_cndmask_b32 v146, v146, 0, s[60:61]
    v_cndmask_b32 v131, v131, 0, s[60:61]
    v_cndmask_b32 v147, v147, 0, s[60:61]
    v_pk_add_f32 v[148:149], v[116:117], v[118:119]
    v_pk_add_f32 v[150:151], v[132:133], v[134:135]
    v_pk_add_f32 v[148:149], v[148:149], v[120:121]
    v_pk_add_f32 v[150:151], v[150:151], v[136:137]
    v_pk_add_f32 v[148:149], v[148:149], v[122:123]
    v_pk_add_f32 v[150:151], v[150:151], v[138:139]
    v_pk_add_f32 v[148:149], v[148:149], v[124:125]
    v_pk_add_f32 v[150:151], v[150:151], v[140:141]
    v_pk_add_f32 v[148:149], v[148:149], v[126:127]
    v_pk_add_f32 v[150:151], v[150:151], v[142:143]
    v_pk_add_f32 v[148:149], v[148:149], v[128:129]
    v_pk_add_f32 v[150:151], v[150:151], v[144:145]
    v_pk_add_f32 v[148:149], v[148:149], v[130:131]
    v_pk_add_f32 v[150:151], v[150:151], v[146:147]
    v_add_f32 v148, v148, v149
    v_add_f32 v149, v150, v151
    v_mov_b32 v150, v148
    v_mov_b32 v151, v149
    s_nop 1
    v_permlane32_swap_b32 v148, v150
    v_permlane32_swap_b32 v149, v151
    s_nop 1
    v_add_f32 v148, v148, v150
    v_add_f32 v149, v149, v151
    v_rcp_f32 v148, v148
    v_rcp_f32 v149, v149
    s_nop 0
    v_pk_mul_f32 v[116:117], v[116:117], v[148:149] op_sel_hi:[1,0]
    v_pk_mul_f32 v[132:133], v[132:133], v[148:149] op_sel:[0,1] op_sel_hi:[1,1]
    v_pk_mul_f32 v[118:119], v[118:119], v[148:149] op_sel_hi:[1,0]
    v_pk_mul_f32 v[134:135], v[134:135], v[148:149] op_sel:[0,1] op_sel_hi:[1,1]
    v_pk_mul_f32 v[120:121], v[120:121], v[148:149] op_sel_hi:[1,0]
    v_pk_mul_f32 v[136:137], v[136:137], v[148:149] op_sel:[0,1] op_sel_hi:[1,1]
    v_pk_mul_f32 v[122:123], v[122:123], v[148:149] op_sel_hi:[1,0]
    v_pk_mul_f32 v[138:139], v[138:139], v[148:149] op_sel:[0,1] op_sel_hi:[1,1]
    v_pk_mul_f32 v[124:125], v[124:125], v[148:149] op_sel_hi:[1,0]
    v_pk_mul_f32 v[140:141], v[140:141], v[148:149] op_sel:[0,1] op_sel_hi:[1,1]
    v_pk_mul_f32 v[126:127], v[126:127], v[148:149] op_sel_hi:[1,0]
    v_pk_mul_f32 v[142:143], v[142:143], v[148:149] op_sel:[0,1] op_sel_hi:[1,1]
    v_pk_mul_f32 v[128:129], v[128:129], v[148:149] op_sel_hi:[1,0]
    v_pk_mul_f32 v[144:145], v[144:145], v[148:149] op_sel:[0,1] op_sel_hi:[1,1]
    v_pk_mul_f32 v[130:131], v[130:131], v[148:149] op_sel_hi:[1,0]
    v_pk_mul_f32 v[146:147], v[146:147], v[148:149] op_sel:[0,1] op_sel_hi:[1,1]
    v_cvt_pk_bf16_f32 v16, v116, v117
    v_cvt_pk_bf16_f32 v17, v118, v119
    v_cvt_pk_bf16_f32 v18, v120, v121
    v_cvt_pk_bf16_f32 v19, v122, v123
    v_cvt_pk_bf16_f32 v20, v124, v125
    v_cvt_pk_bf16_f32 v21, v126, v127
    v_cvt_pk_bf16_f32 v22, v128, v129
    v_cvt_pk_bf16_f32 v23, v130, v131
    v_cvt_pk_bf16_f32 v24, v132, v133
    v_cvt_pk_bf16_f32 v25, v134, v135
    v_cvt_pk_bf16_f32 v26, v136, v137
    v_cvt_pk_bf16_f32 v27, v138, v139
    v_cvt_pk_bf16_f32 v28, v140, v141
    v_cvt_pk_bf16_f32 v29, v142, v143
    v_cvt_pk_bf16_f32 v30, v144, v145
    v_cvt_pk_bf16_f32 v31, v146, v147
    s_lshl_b32 s58, s53, 4
    s_add_u32 s58, s58, s50
    s_lshl_b32 s58, s58, 12
    s_add_u32 s58, s58, s83
    buffer_store_dwordx4 v[16:19], v1, s[28:31], s58 offen offset:0 sc1
    buffer_store_dwordx4 v[20:23], v1, s[28:31], s58 offen offset:1024 sc1
    buffer_store_dwordx4 v[24:27], v1, s[28:31], s58 offen offset:2048 sc1
    buffer_store_dwordx4 v[28:31], v1, s[28:31], s58 offen offset:3072 sc1
    s_barrier
    s_branch P1J2
P1KV2:
    ds_read_b128 v[16:19], v1 offset:28672
    ds_read_b128 v[24:27], v1 offset:29696
    s_waitcnt vmcnt(15) lgkmcnt(1)
    v_mfma_f32_32x32x16_bf16 v[32:47], v[16:19], a[0:3], 0
    s_add_u32 s57, s64, 16384
    buffer_load_dwordx4 a[0:3], v1, s[28:31], s57 offen offset:0
    ds_read_b128 v[16:19], v1 offset:30720
    s_waitcnt vmcnt(15) lgkmcnt(1)
    v_mfma_f32_32x32x16_bf16 v[32:47], v[24:27], a[4:7], v[32:47]
    s_add_u32 s57, s64, 16384
    buffer_load_dwordx4 a[4:7], v1, s[28:31], s57 offen offset:1024
    ds_read_b128 v[24:27], v1 offset:31744
    s_waitcnt vmcnt(15) lgkmcnt(1)
    v_mfma_f32_32x32x16_bf16 v[32:47], v[16:19], a[8:11], v[32:47]
    s_add_u32 s57, s64, 16384
    buffer_load_dwordx4 a[8:11], v1, s[28:31], s57 offen offset:2048
    ds_read_b128 v[16:19], v1 offset:32768
    s_waitcnt vmcnt(15) lgkmcnt(1)
    v_mfma_f32_32x32x16_bf16 v[32:47], v[24:27], a[12:15], v[32:47]
    s_add_u32 s57, s64, 16384
    buffer_load_dwordx4 a[12:15], v1, s[28:31], s57 offen offset:3072
    ds_read_b128 v[24:27], v1 offset:33792
    s_waitcnt vmcnt(15) lgkmcnt(1)
    v_mfma_f32_32x32x16_bf16 v[32:47], v[16:19], a[16:19], v[32:47]
    s_add_u32 s57, s64, 20480
    buffer_load_dwordx4 a[16:19], v1, s[28:31], s57 offen offset:0
    ds_read_b128 v[16:19], v1 offset:34816
    s_waitcnt vmcnt(15) lgkmcnt(1)
    v_mfma_f32_32x32x16_bf16 v[32:47], v[24:27], a[20:23], v[32:47]
    s_add_u32 s57, s64, 20480
    buffer_load_dwordx4 a[20:23], v1, s[28:31], s57 offen offset:1024
    ds_read_b128 v[24:27], v1 offset:35840
    s_waitcnt vmcnt(15) lgkmcnt(1)
    v_mfma_f32_32x32x16_bf16 v[32:47], v[16:19], a[24:27], v[32:47]
    s_add_u32 s57, s64, 20480
    buffer_load_dwordx4 a[24:27], v1, s[28:31], s57 offen offset:2048
    ds_read_b128 v[16:19], v1 offset:36864
    s_waitcnt vmcnt(15) lgkmcnt(1)
    v_mfma_f32_32x32x16_bf16 v[32:47], v[24:27], a[28:31], v[32:47]
    s_add_u32 s57, s64, 20480
    buffer_load_dwordx4 a[28:31], v1, s[28:31], s57 offen offset:3072
    ds_read_b128 v[24:27], v1 offset:37888
    s_waitcnt vmcnt(15) lgkmcnt(1)
    v_mfma_f32_32x32x16_bf16 v[32:47], v[16:19], a[32:35], v[32:47]
    s_add_u32 s57, s64, 24576
    buffer_load_dwordx4 a[32:35], v1, s[28:31], s57 offen offset:0
    ds_read_b128 v[16:19], v1 offset:38912
    s_waitcnt vmcnt(15) lgkmcnt(1)
    v_mfma_f32_32x32x16_bf16 v[32:47], v[24:27], a[36:39], v[32:47]
    s_add_u32 s57, s64, 24576
    buffer_load_dwordx4 a[36:39], v1, s[28:31], s57 offen offset:1024
    ds_read_b128 v[24:27], v1 offset:39936
    s_waitcnt vmcnt(15) lgkmcnt(1)
    v_mfma_f32_32x32x16_bf16 v[32:47], v[16:19], a[40:43], v[32:47]
    s_add_u32 s57, s64, 24576
    buffer_load_dwordx4 a[40:43], v1, s[28:31], s57 offen offset:2048
    ds_read_b128 v[16:19], v1 offset:40960
    s_waitcnt vmcnt(15) lgkmcnt(1)
    v_mfma_f32_32x32x16_bf16 v[32:47], v[24:27], a[44:47], v[32:47]
    s_add_u32 s57, s64, 24576
    buffer_load_dwordx4 a[44:47], v1, s[28:31], s57 offen offset:3072
    ds_read_b128 v[24:27], v1 offset:41984
    s_waitcnt vmcnt(15) lgkmcnt(1)
    v_mfma_f32_32x32x16_bf16 v[32:47], v[16:19], a[48:51], v[32:47]
    ds_read_b128 v[16:19], v1 offset:43008
    s_waitcnt vmcnt(14) lgkmcnt(1)
    v_mfma_f32_32x32x16_bf16 v[32:47], v[24:27], a[52:55], v[32:47]
    ds_read_b128 v[24:27], v1 offset:44032
    s_waitcnt vmcnt(13) lgkmcnt(1)
    v_mfma_f32_32x32x16_bf16 v[32:47], v[16:19], a[56:59], v[32:47]
    ds_read_b128 v[16:19], v1 offset:45056
    s_waitcnt vmcnt(12) lgkmcnt(1)
    v_mfma_f32_32x32x16_bf16 v[32:47], v[24:27], a[60:63], v[32:47]
    ds_read_b128 v[24:27], v1 offset:46080
    s_waitcnt vmcnt(11) lgkmcnt(1)
    v_mfma_f32_32x32x16_bf16 v[32:47], v[16:19], a[0:3], v[32:47]
    ds_read_b128 v[16:19], v1 offset:47104
    s_waitcnt vmcnt(10) lgkmcnt(1)
    v_mfma_f32_32x32x16_bf16 v[32:47], v[24:27], a[4:7], v[32:47]
    ds_read_b128 v[24:27], v1 offset:48128
    s_waitcnt vmcnt(9) lgkmcnt(1)
    v_mfma_f32_32x32x16_bf16 v[32:47], v[16:19], a[8:11], v[32:47]
    ds_read_b128 v[16:19], v1 offset:49152
    s_waitcnt vmcnt(8) lgkmcnt(1)
    v_mfma_f32_32x32x16_bf16 v[32:47], v[24:27], a[12:15], v[32:47]
    ds_read_b128 v[24:27], v1 offset:50176
    s_waitcnt vmcnt(7) lgkmcnt(1)
    v_mfma_f32_32x32x16_bf16 v[32:47], v[16:19], a[16:19], v[32:47]
    ds_read_b128 v[16:19], v1 offset:51200
    s_waitcnt vmcnt(6) lgkmcnt(1)
    v_mfma_f32_32x32x16_bf16 v[32:47], v[24:27], a[20:23], v[32:47]
    ds_read_b128 v[24:27], v1 offset:52224
    s_waitcnt vmcnt(5) lgkmcnt(1)
    v_mfma_f32_32x32x16_bf16 v[32:47], v[16:19], a[24:27], v[32:47]
    ds_read_b128 v[16:19], v1 offset:53248
    s_waitcnt vmcnt(4) lgkmcnt(1)
    v_mfma_f32_32x32x16_bf16 v[32:47], v[24:27], a[28:31], v[32:47]
    ds_read_b128 v[24:27], v1 offset:54272
    s_waitcnt vmcnt(3) lgkmcnt(1)
    v_mfma_f32_32x32x16_bf16 v[32:47], v[16:19], a[32:35], v[32:47]
    ds_read_b128 v[16:19], v1 offset:55296
    s_waitcnt vmcnt(2) lgkmcnt(1)
    v_mfma_f32_32x32x16_bf16 v[32:47], v[24:27], a[36:39], v[32:47]
    ds_read_b128 v[24:27], v1 offset:56320
    s_waitcnt vmcnt(1) lgkmcnt(1)
    v_mfma_f32_32x32x16_bf16 v[32:47], v[16:19], a[40:43], v[32:47]
    s_waitcnt vmcnt(0) lgkmcnt(0)
    v_mfma_f32_32x32x16_bf16 v[32:47], v[24:27], a[44:47], v[32:47]
    v_mul_f32 v96, 0x3b124925, v96
    v_mul_f32 v97, 0x3b124925, v97
    v_fma_f32 v97, -v96, v96, v97
    v_max_f32 v97, 0, v97
    v_cvt_pk_bf16_f32 v98, v97, v96
    v_lshlrev_b32 v99, 16, v98
    v_and_b32 v98, 0xffff0000, v98
    v_add_f32 v99, 0x3727c5ac, v99
    v_cvt_pk_bf16_f32 v99, v99, v99
    v_lshlrev_b32 v99, 16, v99
    v_sqrt_f32 v99, v99
    s_nop 0
    v_cvt_pk_bf16_f32 v99, v99, v99
    v_lshlrev_b32 v99, 16, v99
    v_rcp_f32 v96, v99
    s_nop 0
    v_mul_f32 v97, v98, v96
    v_sub_f32 v97, 0, v97
    s_nop 3
    v_pk_mul_f32 v[98:99], v[64:65], v[96:97] op_sel:[0,1] op_sel_hi:[1,1]
    v_pk_fma_f32 v[32:33], v[32:33], v[96:97], v[98:99] op_sel_hi:[1,0,1]
    v_pk_mul_f32 v[98:99], v[66:67], v[96:97] op_sel:[0,1] op_sel_hi:[1,1]
    v_pk_fma_f32 v[34:35], v[34:35], v[96:97], v[98:99] op_sel_hi:[1,0,1]
    v_pk_mul_f32 v[98:99], v[68:69], v[96:97] op_sel:[0,1] op_sel_hi:[1,1]
    v_pk_fma_f32 v[36:37], v[36:37], v[96:97], v[98:99] op_sel_hi:[1,0,1]
    v_pk_mul_f32 v[98:99], v[70:71], v[96:97] op_sel:[0,1] op_sel_hi:[1,1]
    v_pk_fma_f32 v[38:39], v[38:39], v[96:97], v[98:99] op_sel_hi:[1,0,1]
    v_pk_mul_f32 v[98:99], v[72:73], v[96:97] op_sel:[0,1] op_sel_hi:[1,1]
    v_pk_fma_f32 v[40:41], v[40:41], v[96:97], v[98:99] op_sel_hi:[1,0,1]
    v_pk_mul_f32 v[98:99], v[74:75], v[96:97] op_sel:[0,1] op_sel_hi:[1,1]
    v_pk_fma_f32 v[42:43], v[42:43], v[96:97], v[98:99] op_sel_hi:[1,0,1]
    v_pk_mul_f32 v[98:99], v[76:77], v[96:97] op_sel:[0,1] op_sel_hi:[1,1]
    v_pk_fma_f32 v[44:45], v[44:45], v[96:97], v[98:99] op_sel_hi:[1,0,1]
    v_pk_mul_f32 v[98:99], v[78:79], v[96:97] op_sel:[0,1] op_sel_hi:[1,1]
    v_pk_fma_f32 v[46:47], v[46:47], v[96:97], v[98:99] op_sel_hi:[1,0,1]
    v_cvt_pk_bf16_f32 v16, v32, v33
    v_cvt_pk_bf16_f32 v17, v34, v35
    v_cvt_pk_bf16_f32 v18, v36, v37
    v_cvt_pk_bf16_f32 v19, v38, v39
    v_cvt_pk_bf16_f32 v20, v40, v41
    v_cvt_pk_bf16_f32 v21, v42, v43
    v_cvt_pk_bf16_f32 v22, v44, v45
    v_cvt_pk_bf16_f32 v23, v46, v47
    s_nop 1
    v_mfma_f32_32x32x16_bf16 v[32:47], a[64:67], v[16:19], 0
    v_mfma_f32_32x32x16_bf16 v[32:47], a[68:71], v[20:23], v[32:47]
    v_and_b32 v13, 15, v2
    v_lshrrev_b32 v14, 2, v13
    v_lshl_add_u32 v14, v11, 2, v14
    v_and_b32 v13, 3, v13
    v_lshlrev_b32 v13, 3, v13
    v_bfe_u32 v15, v2, 4, 1
    v_lshl_add_u32 v13, v15, 5, v13
    v_mul_u32_u24 v15, 72, v14
    v_mul_u32_u24 v14, 136, v14
    v_add3_u32 v14, v14, v13, s59
    v_add3_u32 v15, v15, v13, s59
    v_mul_u32_u24 v12, 136, v10
    v_lshl_add_u32 v12, v11, 3, v12
    v_add_u32 v12, s59, v12
    v_cvt_pk_bf16_f32 v16, v32, v33
    v_cvt_pk_bf16_f32 v17, v34, v35
    v_cvt_pk_bf16_f32 v18, v36, v37
    v_cvt_pk_bf16_f32 v19, v38, v39
    v_cvt_pk_bf16_f32 v20, v40, v41
    v_cvt_pk_bf16_f32 v21, v42, v43
    v_cvt_pk_bf16_f32 v22, v44, v45
    v_cvt_pk_bf16_f32 v23, v46, v47
    v_lshlrev_b32 v100, 16, v16
    v_and_b32 v101, 0xffff0000, v16
    v_lshlrev_b32 v102, 16, v17
    v_and_b32 v103, 0xffff0000, v17
    v_lshlrev_b32 v104, 16, v18
    v_and_b32 v105, 0xffff0000, v18
    v_lshlrev_b32 v106, 16, v19
    v_and_b32 v107, 0xffff0000, v19
    v_lshlrev_b32 v108, 16, v20
    v_and_b32 v109, 0xffff0000, v20
    v_lshlrev_b32 v110, 16, v21
    v_and_b32 v111, 0xffff0000, v21
    v_lshlrev_b32 v112, 16, v22
    v_and_b32 v113, 0xffff0000, v22
    v_lshlrev_b32 v114, 16, v23
    v_and_b32 v115, 0xffff0000, v23
    v_cndmask_b32 v112, v112, v100, s[60:61]
    v_cndmask_b32 v113, v113, v100, s[60:61]
    v_cndmask_b32 v114, v114, v100, s[60:61]
    v_cndmask_b32 v115, v115, v100, s[60:61]
    v_max3_f32 v148, v100, v101, v102
    v_min3_f32 v149, v100, v101, v102
    v_max3_f32 v148, v148, v103, v104
    v_min3_f32 v149, v149, v103, v104
    v_max3_f32 v148, v148, v105, v106
    v_min3_f32 v149, v149, v105, v106
    v_max3_f32 v148, v148, v107, v108
    v_min3_f32 v149, v149, v107, v108
    v_max3_f32 v148, v148, v109, v110
    v_min3_f32 v149, v149, v109, v110
    v_max3_f32 v148, v148, v111, v112
    v_min3_f32 v149, v149, v111, v112
    v_max3_f32 v148, v148, v113, v114
    v_min3_f32 v149, v149, v113, v114
    v_max_f32 v148, v148, v115
    v_min_f32 v149, v149, v115
    v_mov_b32 v150, v148
    v_mov_b32 v151, v149
    s_nop 1
    v_permlane32_swap_b32 v148, v150
    v_permlane32_swap_b32 v149, v151
    s_nop 1
    v_max_f32 v148, v148, v150
    v_min_f32 v149, v149, v151
    v_mul_f32 v148, 0xbfb8aa3b, v148
    v_mul_f32 v149, 0x3fb8aa3b, v149
    v_mov_b32 v152, 0x3fb8aa3b
    v_fma_f32 v116, v100, v152, v148
    v_fma_f32 v132, -v100, v152, v149
    v_fma_f32 v117, v101, v152, v148
    v_fma_f32 v133, -v101, v152, v149
    v_fma_f32 v118, v102, v152, v148
    v_fma_f32 v134, -v102, v152, v149
    v_fma_f32 v119, v103, v152, v148
    v_fma_f32 v135, -v103, v152, v149
    v_fma_f32 v120, v104, v152, v148
    v_fma_f32 v136, -v104, v152, v149
    v_fma_f32 v121, v105, v152, v148
    v_fma_f32 v137, -v105, v152, v149
    v_fma_f32 v122, v106, v152, v148
    v_fma_f32 v138, -v106, v152, v149
    v_fma_f32 v123, v107, v152, v148
    v_fma_f32 v139, -v107, v152, v149
    v_fma_f32 v124, v108, v152, v148
    v_fma_f32 v140, -v108, v152, v149
    v_fma_f32 v125, v109, v152, v148
    v_fma_f32 v141, -v109, v152, v149
    v_fma_f32 v126, v110, v152, v148
    v_fma_f32 v142, -v110, v152, v149
    v_fma_f32 v127, v111, v152, v148
    v_fma_f32 v143, -v111, v152, v149
    v_fma_f32 v128, v112, v152, v148
    v_fma_f32 v144, -v112, v152, v149
    v_fma_f32 v129, v113, v152, v148
    v_fma_f32 v145, -v113, v152, v149
    v_fma_f32 v130, v114, v152, v148
    v_fma_f32 v146, -v114, v152, v149
    v_fma_f32 v131, v115, v152, v148
    v_fma_f32 v147, -v115, v152, v149
    v_exp_f32 v116, v116
    v_exp_f32 v117, v117
    v_exp_f32 v118, v118
    v_exp_f32 v119, v119
    v_exp_f32 v120, v120
    v_exp_f32 v121, v121
    v_exp_f32 v122, v122
    v_exp_f32 v123, v123
    v_exp_f32 v124, v124
    v_exp_f32 v125, v125
    v_exp_f32 v126, v126
    v_exp_f32 v127, v127
    v_exp_f32 v128, v128
    v_exp_f32 v129, v129
    v_exp_f32 v130, v130
    v_exp_f32 v131, v131
    v_exp_f32 v132, v132
    v_exp_f32 v133, v133
    v_exp_f32 v134, v134
    v_exp_f32 v135, v135
    v_exp_f32 v136, v136
    v_exp_f32 v137, v137
    v_exp_f32 v138, v138
    v_exp_f32 v139, v139
    v_exp_f32 v140, v140
    v_exp_f32 v141, v141
    v_exp_f32 v142, v142
    v_exp_f32 v143, v143
    v_exp_f32 v144, v144
    v_exp_f32 v145, v145
    v_exp_f32 v146, v146
    v_exp_f32 v147, v147
    s_nop 0
    v_cndmask_b32 v128, v128, 0, s[60:61]
    v_cndmask_b32 v144, v144, 0, s[60:61]
    v_cndmask_b32 v129, v129, 0, s[60:61]
    v_cndmask_b32 v145, v145, 0, s[60:61]
    v_cndmask_b32 v130, v130, 0, s[60:61]
    v_cndmask_b32 v146, v146, 0, s[60:61]
    v_cndmask_b32 v131, v131, 0, s[60:61]
    v_cndmask_b32 v147, v147, 0, s[60:61]
    v_pk_add_f32 v[148:149], v[116:117], v[118:119]
    v_pk_add_f32 v[150:151], v[132:133], v[134:135]
    v_pk_add_f32 v[148:149], v[148:149], v[120:121]
    v_pk_add_f32 v[150:151], v[150:151], v[136:137]
    v_pk_add_f32 v[148:149], v[148:149], v[122:123]
    v_pk_add_f32 v[150:151], v[150:151], v[138:139]
    v_pk_add_f32 v[148:149], v[148:149], v[124:125]
    v_pk_add_f32 v[150:151], v[150:151], v[140:141]
    v_pk_add_f32 v[148:149], v[148:149], v[126:127]
    v_pk_add_f32 v[150:151], v[150:151], v[142:143]
    v_pk_add_f32 v[148:149], v[148:149], v[128:129]
    v_pk_add_f32 v[150:151], v[150:151], v[144:145]
    v_pk_add_f32 v[148:149], v[148:149], v[130:131]
    v_pk_add_f32 v[150:151], v[150:151], v[146:147]
    v_add_f32 v148, v148, v149
    v_add_f32 v149, v150, v151
    v_mov_b32 v150, v148
    v_mov_b32 v151, v149
    s_nop 1
    v_permlane32_swap_b32 v148, v150
    v_permlane32_swap_b32 v149, v151
    s_nop 1
    v_add_f32 v148, v148, v150
    v_add_f32 v149, v149, v151
    v_rcp_f32 v148, v148
    v_rcp_f32 v149, v149
    s_nop 0
    v_pk_mul_f32 v[116:117], v[116:117], v[148:149] op_sel_hi:[1,0]
    v_pk_mul_f32 v[132:133], v[132:133], v[148:149] op_sel:[0,1] op_sel_hi:[1,1]
    v_pk_mul_f32 v[118:119], v[118:119], v[148:149] op_sel_hi:[1,0]
    v_pk_mul_f32 v[134:135], v[134:135], v[148:149] op_sel:[0,1] op_sel_hi:[1,1]
    v_pk_mul_f32 v[120:121], v[120:121], v[148:149] op_sel_hi:[1,0]
    v_pk_mul_f32 v[136:137], v[136:137], v[148:149] op_sel:[0,1] op_sel_hi:[1,1]
    v_pk_mul_f32 v[122:123], v[122:123], v[148:149] op_sel_hi:[1,0]
    v_pk_mul_f32 v[138:139], v[138:139], v[148:149] op_sel:[0,1] op_sel_hi:[1,1]
    v_pk_mul_f32 v[124:125], v[124:125], v[148:149] op_sel_hi:[1,0]
    v_pk_mul_f32 v[140:141], v[140:141], v[148:149] op_sel:[0,1] op_sel_hi:[1,1]
    v_pk_mul_f32 v[126:127], v[126:127], v[148:149] op_sel_hi:[1,0]
    v_pk_mul_f32 v[142:143], v[142:143], v[148:149] op_sel:[0,1] op_sel_hi:[1,1]
    v_pk_mul_f32 v[128:129], v[128:129], v[148:149] op_sel_hi:[1,0]
    v_pk_mul_f32 v[144:145], v[144:145], v[148:149] op_sel:[0,1] op_sel_hi:[1,1]
    v_pk_mul_f32 v[130:131], v[130:131], v[148:149] op_sel_hi:[1,0]
    v_pk_mul_f32 v[146:147], v[146:147], v[148:149] op_sel:[0,1] op_sel_hi:[1,1]
    v_cvt_pk_bf16_f32 v16, v116, v117
    v_cvt_pk_bf16_f32 v17, v118, v119
    v_cvt_pk_bf16_f32 v18, v120, v121
    v_cvt_pk_bf16_f32 v19, v122, v123
    v_cvt_pk_bf16_f32 v20, v124, v125
    v_cvt_pk_bf16_f32 v21, v126, v127
    v_cvt_pk_bf16_f32 v22, v128, v129
    v_cvt_pk_bf16_f32 v23, v130, v131
    v_cvt_pk_bf16_f32 v24, v132, v133
    v_cvt_pk_bf16_f32 v25, v134, v135
    v_cvt_pk_bf16_f32 v26, v136, v137
    v_cvt_pk_bf16_f32 v27, v138, v139
    v_cvt_pk_bf16_f32 v28, v140, v141
    v_cvt_pk_bf16_f32 v29, v142, v143
    v_cvt_pk_bf16_f32 v30, v144, v145
    v_cvt_pk_bf16_f32 v31, v146, v147
    ds_write_b64 v12, v[16:17] offset:0
    ds_write_b64 v12, v[18:19] offset:16
    ds_write_b64 v12, v[20:21] offset:32
    ds_write_b64 v12, v[22:23] offset:48
    ds_write_b64 v12, v[24:25] offset:64
    ds_write_b64 v12, v[26:27] offset:80
    ds_write_b64 v12, v[28:29] offset:96
    ds_write_b64 v12, v[30:31] offset:112
    s_waitcnt lgkmcnt(0)
    s_barrier
    ds_read_b64_tr_b16 v[100:101], v14 offset:0
    ds_read_b64_tr_b16 v[102:103], v14 offset:1088
    ds_read_b64_tr_b16 v[104:105], v14 offset:2176
    ds_read_b64_tr_b16 v[106:107], v14 offset:3264
    ds_read_b64_tr_b16 v[108:109], v14 offset:64
    ds_read_b64_tr_b16 v[110:111], v14 offset:1152
    ds_read_b64_tr_b16 v[112:113], v14 offset:2240
    ds_read_b64_tr_b16 v[114:115], v14 offset:3328
    ds_read_b64_tr_b16 v[116:117], v15 offset:4352
    ds_read_b64_tr_b16 v[118:119], v15 offset:4928
    ds_read_b64_tr_b16 v[120:121], v15 offset:5504
    ds_read_b64_tr_b16 v[122:123], v15 offset:6080
    s_waitcnt lgkmcnt(0)
    s_nop 1
    v_mfma_f32_32x32x16_bf16 v[32:47], v[116:119], v[100:103], 0
    v_mfma_f32_32x32x16_bf16 v[32:47], v[120:123], v[104:107], v[32:47]
    v_mfma_f32_32x32x16_bf16 v[48:63], v[116:119], v[108:111], 0
    v_mfma_f32_32x32x16_bf16 v[48:63], v[120:123], v[112:115], v[48:63]
    v_add_u32 v12, s59, v1
    s_nop 13
    ds_write_b128 v12, v[32:35] offset:0
    ds_write_b128 v12, v[36:39] offset:1024
    ds_write_b128 v12, v[40:43] offset:2048
    ds_write_b128 v12, v[44:47] offset:3072
    ds_write_b128 v12, v[48:51] offset:4096
    ds_write_b128 v12, v[52:55] offset:5120
    ds_write_b128 v12, v[56:59] offset:6144
    ds_write_b128 v12, v[60:63] offset:7168
    s_waitcnt lgkmcnt(0)
    s_barrier
    s_lshl_b32 s57, s75, 11
    s_add_u32 s57, s57, 86016
    v_add_u32 v12, s57, v1
    ds_read_b128 v[32:35], v12 offset:0
    ds_read_b128 v[36:39], v12 offset:1024
    ds_read_b128 v[40:43], v12 offset:8192
    ds_read_b128 v[44:47], v12 offset:9216
    ds_read_b128 v[48:51], v12 offset:16384
    ds_read_b128 v[52:55], v12 offset:17408
    ds_read_b128 v[56:59], v12 offset:24576
    ds_read_b128 v[60:63], v12 offset:25600
    s_waitcnt lgkmcnt(0)
    v_pk_add_f32 v[32:33], v[32:33], v[40:41]
    v_pk_add_f32 v[48:49], v[48:49], v[56:57]
    v_pk_add_f32 v[34:35], v[34:35], v[42:43]
    v_pk_add_f32 v[50:51], v[50:51], v[58:59]
    v_pk_add_f32 v[36:37], v[36:37], v[44:45]
    v_pk_add_f32 v[52:53], v[52:53], v[60:61]
    v_pk_add_f32 v[38:39], v[38:39], v[46:47]
    v_pk_add_f32 v[54:55], v[54:55], v[62:63]
    v_pk_add_f32 v[32:33], v[32:33], v[48:49]
    v_pk_add_f32 v[34:35], v[34:35], v[50:51]
    v_pk_add_f32 v[36:37], v[36:37], v[52:53]
    v_pk_add_f32 v[38:39], v[38:39], v[54:55]
    s_lshl_b32 s57, s50, 13
    s_add_u32 s57, s57, s85
    s_lshr_b32 s58, s75, 1
    s_lshl_b32 s58, s58, 7
    s_add_u32 s57, s57, s58
    s_and_b32 s58, s75, 1
    s_lshl_b32 s58, s58, 12
    s_add_u32 s57, s57, s58
    v_lshlrev_b32 v12, 2, v10
    v_lshl_add_u32 v12, v11, 10, v12
    buffer_atomic_add_f32 v32, v12, s[28:31], s57 offen offset:0
    buffer_atomic_add_f32 v33, v12, s[28:31], s57 offen offset:256
    buffer_atomic_add_f32 v34, v12, s[28:31], s57 offen offset:512
    buffer_atomic_add_f32 v35, v12, s[28:31], s57 offen offset:768
    buffer_atomic_add_f32 v36, v12, s[28:31], s57 offen offset:2048
    buffer_atomic_add_f32 v37, v12, s[28:31], s57 offen offset:2304
    buffer_atomic_add_f32 v38, v12, s[28:31], s57 offen offset:2560
    buffer_atomic_add_f32 v39, v12, s[28:31], s57 offen offset:2816
P1J2:
    s_waitcnt vmcnt(0) lgkmcnt(0)
    s_barrier
    s_cmp_lg_u32 s52, 0
    s_cbranch_scc1 SIG3
    s_lshl_b32 s57, s50, 7
    s_add_u32 s57, s57, s89
    v_mov_b32 v3, 1
    v_mov_b32 v9, 0
    s_mov_b64 exec, 1
    buffer_atomic_add v3, v9, s[28:31], s57 offen sc1
    s_mov_b64 exec, -1
SIG3:
    s_lshl_b32 s58, s70, 1
    s_add_u32 s58, s58, 0
    s_lshl_b32 s58, s58, 4
    s_lshl_b32 s59, s52, 1
    s_add_u32 s58, s58, s59
    s_add_u32 s58, s58, 0
    s_lshl_b32 s58, s58, 11
    s_add_u32 s58, s58, 1409024
    buffer_load_dwordx4 a[64:67], v1, s[28:31], s58 offen offset:0
    buffer_load_dwordx4 a[68:71], v1, s[28:31], s58 offen offset:1024
    s_lshl_b32 s58, s70, 1
    s_add_u32 s58, s58, 1
    s_lshl_b32 s58, s58, 4
    s_lshl_b32 s59, s52, 1
    s_add_u32 s58, s58, s59
    s_add_u32 s58, s58, 0
    s_lshl_b32 s58, s58, 11
    s_add_u32 s58, s58, 1409024
    buffer_load_dwordx4 a[72:75], v1, s[28:31], s58 offen offset:0
    buffer_load_dwordx4 a[76:79], v1, s[28:31], s58 offen offset:1024
    s_lshl_b32 s58, s70, 1
    s_add_u32 s58, s58, 0
    s_lshl_b32 s58, s58, 4
    s_lshl_b32 s59, s52, 1
    s_add_u32 s58, s58, s59
    s_add_u32 s58, s58, 1
    s_lshl_b32 s58, s58, 11
    s_add_u32 s58, s58, 1409024
    buffer_load_dwordx4 a[80:83], v1, s[28:31], s58 offen offset:0
    buffer_load_dwordx4 a[84:87], v1, s[28:31], s58 offen offset:1024
    s_lshl_b32 s58, s70, 1
    s_add_u32 s58, s58, 1
    s_lshl_b32 s58, s58, 4
    s_lshl_b32 s59, s52, 1
    s_add_u32 s58, s58, s59
    s_add_u32 s58, s58, 1
    s_lshl_b32 s58, s58, 11
    s_add_u32 s58, s58, 1409024
    buffer_load_dwordx4 a[88:91], v1, s[28:31], s58 offen offset:0
    buffer_load_dwordx4 a[92:95], v1, s[28:31], s58 offen offset:1024
    s_bfe_u32 s62, s52, 0x10001
    s_lshl_b32 s59, s71, 1
    s_add_u32 s62, s62, s59
    s_mul_i32 s63, s62, 28
    s_lshl_b32 s59, s70, 2
    s_add_u32 s63, s63, s59
    s_and_b32 s59, s52, 1
    s_lshl_b32 s59, s59, 1
    s_add_u32 s63, s63, s59
    s_lshl_b32 s63, s63, 10
    v_lshlrev_b32 v13, 4, v10
    v_lshl_add_u32 v13, v11, 10, v13
    s_mul_i32 s59, s52, 8704
    v_lshrrev_b32 v8, 4, v2
    v_mul_u32_u24 v8, 136, v8
    v_and_b32 v12, 15, v2
    v_lshl_add_u32 v8, v12, 3, v8
    v_add_u32 v8, s59, v8
    v_mul_u32_u24 v12, 136, v10
    v_lshl_add_u32 v12, v11, 3, v12
    v_add_u32 v12, s59, v12
    s_cmp_ge_u32 s2, 224
    s_cbranch_scc1 M_SKIP
    s_cmp_lg_u32 s52, 0
    s_cbranch_scc1 WT4_P
    s_mov_b32 s57, s89
    v_lshlrev_b32 v9, 7, v2
    s_mov_b64 exec, 65535
    s_mov_b32 s58, 0
WT4_L:
    buffer_load_dword v3, v9, s[28:31], s57 offen sc1
    s_waitcnt vmcnt(0)
    v_cmp_gt_u32 vcc, 16, v3
    s_add_u32 s58, s58, 1
    s_cmp_eq_u64 vcc, 0
    s_cbranch_scc1 WT4_E
    s_sleep 1
    s_cmp_lt_u32 s58, 0x40000
    s_cbranch_scc1 WT4_L
WT4_E:
    s_mov_b64 exec, -1
    s_barrier
    s_branch WT4_D
WT4_P:
    s_barrier
WT4_D:
    s_lshl_b32 s64, s52, 14
    s_add_u32 s64, s64, s85
    s_add_u32 s57, s64, 0
    buffer_load_dwordx4 v[16:19], v1, s[28:31], s57 offen offset:0
    buffer_load_dwordx4 v[20:23], v1, s[28:31], s57 offen offset:1024
    buffer_load_dwordx4 v[24:27], v1, s[28:31], s57 offen offset:2048
    buffer_load_dwordx4 v[28:31], v1, s[28:31], s57 offen offset:3072
    s_add_u32 s57, s64, 4096
    buffer_load_dwordx4 v[32:35], v1, s[28:31], s57 offen offset:0
    buffer_load_dwordx4 v[36:39], v1, s[28:31], s57 offen offset:1024
    buffer_load_dwordx4 v[40:43], v1, s[28:31], s57 offen offset:2048
    buffer_load_dwordx4 v[44:47], v1, s[28:31], s57 offen offset:3072
    s_lshl_b32 s58, s71, 1
    s_add_u32 s58, s58, 0
    s_lshl_b32 s58, s58, 4
    s_lshl_b32 s59, s52, 1
    s_add_u32 s58, s58, s59
    s_add_u32 s58, s58, 0
    s_lshl_b32 s58, s58, 12
    s_add_u32 s58, s58, s83
    buffer_load_dwordx4 v[80:83], v1, s[28:31], s58 offen offset:0
    buffer_load_dwordx4 v[84:87], v1, s[28:31], s58 offen offset:1024
    buffer_load_dwordx4 v[88:91], v1, s[28:31], s58 offen offset:2048
    buffer_load_dwordx4 v[92:95], v1, s[28:31], s58 offen offset:3072
    s_lshl_b32 s58, s71, 1
    s_add_u32 s58, s58, 1
    s_lshl_b32 s58, s58, 4
    s_lshl_b32 s59, s52, 1
    s_add_u32 s58, s58, s59
    s_add_u32 s58, s58, 0
    s_lshl_b32 s58, s58, 12
    s_add_u32 s58, s58, s83
    buffer_load_dwordx4 v[96:99], v1, s[28:31], s58 offen offset:0
    buffer_load_dwordx4 v[100:103], v1, s[28:31], s58 offen offset:1024
    buffer_load_dwordx4 v[104:107], v1, s[28:31], s58 offen offset:2048
    buffer_load_dwordx4 v[108:111], v1, s[28:31], s58 offen offset:3072
    s_add_u32 s57, s64, 8192
    buffer_load_dwordx4 v[48:51], v1, s[28:31], s57 offen offset:0
    buffer_load_dwordx4 v[52:55], v1, s[28:31], s57 offen offset:1024
    buffer_load_dwordx4 v[56:59], v1, s[28:31], s57 offen offset:2048
    buffer_load_dwordx4 v[60:63], v1, s[28:31], s57 offen offset:3072
    s_add_u32 s57, s64, 12288
    buffer_load_dwordx4 v[64:67], v1, s[28:31], s57 offen offset:0
    buffer_load_dwordx4 v[68:71], v1, s[28:31], s57 offen offset:1024
    buffer_load_dwordx4 v[72:75], v1, s[28:31], s57 offen offset:2048
    buffer_load_dwordx4 v[76:79], v1, s[28:31], s57 offen offset:3072
    s_lshl_b32 s58, s71, 1
    s_add_u32 s58, s58, 0
    s_lshl_b32 s58, s58, 4
    s_lshl_b32 s59, s52, 1
    s_add_u32 s58, s58, s59
    s_add_u32 s58, s58, 1
    s_lshl_b32 s58, s58, 12
    s_add_u32 s58, s58, s83
    buffer_load_dwordx4 v[112:115], v1, s[28:31], s58 offen offset:0
    buffer_load_dwordx4 v[116:119], v1, s[28:31], s58 offen offset:1024
    buffer_load_dwordx4 v[120:123], v1, s[28:31], s58 offen offset:2048
    buffer_load_dwordx4 v[124:127], v1, s[28:31], s58 offen offset:3072
    s_lshl_b32 s58, s71, 1
    s_add_u32 s58, s58, 1
    s_lshl_b32 s58, s58, 4
    s_lshl_b32 s59, s52, 1
    s_add_u32 s58, s58, s59
    s_add_u32 s58, s58, 1
    s_lshl_b32 s58, s58, 12
    s_add_u32 s58, s58, s83
    buffer_load_dwordx4 v[128:131], v1, s[28:31], s58 offen offset:0
    buffer_load_dwordx4 v[132:135], v1, s[28:31], s58 offen offset:1024
    buffer_load_dwordx4 v[136:139], v1, s[28:31], s58 offen offset:2048
    buffer_load_dwordx4 v[140:143], v1, s[28:31], s58 offen offset:3072
    s_waitcnt vmcnt(24)
    v_cvt_pk_bf16_f32 v16, v16, v17
    v_cvt_pk_bf16_f32 v17, v18, v19
    v_cvt_pk_bf16_f32 v20, v20, v21
    v_cvt_pk_bf16_f32 v21, v22, v23
    v_cvt_pk_bf16_f32 v24, v24, v25
    v_cvt_pk_bf16_f32 v25, v26, v27
    v_cvt_pk_bf16_f32 v28, v28, v29
    v_cvt_pk_bf16_f32 v29, v30, v31
    v_cvt_pk_bf16_f32 v32, v32, v33
    v_cvt_pk_bf16_f32 v33, v34, v35
    v_cvt_pk_bf16_f32 v36, v36, v37
    v_cvt_pk_bf16_f32 v37, v38, v39
    v_cvt_pk_bf16_f32 v40, v40, v41
    v_cvt_pk_bf16_f32 v41, v42, v43
    v_cvt_pk_bf16_f32 v44, v44, v45
    v_cvt_pk_bf16_f32 v45, v46, v47
    ds_write_b64 v8, v[16:17] offset:0
    ds_write_b64 v8, v[20:21] offset:544
    ds_write_b64 v8, v[24:25] offset:1088
    ds_write_b64 v8, v[28:29] offset:1632
    ds_write_b64 v8, v[32:33] offset:2176
    ds_write_b64 v8, v[36:37] offset:2720
    ds_write_b64 v8, v[40:41] offset:3264
    ds_write_b64 v8, v[44:45] offset:3808
    s_waitcnt lgkmcnt(0)
    ds_read_b64 v[144:145], v12 offset:0
    ds_read_b64 v[146:147], v12 offset:16
    ds_read_b64 v[148:149], v12 offset:32
    ds_read_b64 v[150:151], v12 offset:48
    ds_read_b64 v[152:153], v12 offset:64
    ds_read_b64 v[154:155], v12 offset:80
    ds_read_b64 v[156:157], v12 offset:96
    ds_read_b64 v[158:159], v12 offset:112
    s_waitcnt vmcnt(16) lgkmcnt(0)
    v_mfma_f32_32x32x16_bf16 v[16:31], v[144:147], v[80:83], 0
    v_mfma_f32_32x32x16_bf16 v[16:31], v[148:151], v[84:87], v[16:31]
    v_mfma_f32_32x32x16_bf16 v[16:31], v[152:155], v[88:91], v[16:31]
    v_mfma_f32_32x32x16_bf16 v[16:31], v[156:159], v[92:95], v[16:31]
    v_mfma_f32_32x32x16_bf16 v[32:47], v[144:147], v[96:99], 0
    v_mfma_f32_32x32x16_bf16 v[32:47], v[148:151], v[100:103], v[32:47]
    v_mfma_f32_32x32x16_bf16 v[32:47], v[152:155], v[104:107], v[32:47]
    v_mfma_f32_32x32x16_bf16 v[32:47], v[156:159], v[108:111], v[32:47]
    s_nop 13
    v_mov_b32 v14, v28
    v_mov_b32 v15, v28
    s_nop 1
    v_permlane32_swap_b32 v14, v15
    s_nop 1
    v_cvt_pk_bf16_f32 v15, v15, v15
    v_lshlrev_b32 v15, 16, v15
    v_add_f32 v15, 0x358637bd, v15
    v_cvt_pk_bf16_f32 v15, v15, v15
    v_lshlrev_b32 v15, 16, v15
    v_rcp_f32 v14, v15
    s_nop 0
    v_pk_mul_f32 v[16:17], v[16:17], v[14:15] op_sel_hi:[1,0]
    v_pk_mul_f32 v[18:19], v[18:19], v[14:15] op_sel_hi:[1,0]
    v_pk_mul_f32 v[20:21], v[20:21], v[14:15] op_sel_hi:[1,0]
    v_pk_mul_f32 v[22:23], v[22:23], v[14:15] op_sel_hi:[1,0]
    v_pk_mul_f32 v[24:25], v[24:25], v[14:15] op_sel_hi:[1,0]
    v_pk_mul_f32 v[26:27], v[26:27], v[14:15] op_sel_hi:[1,0]
    v_pk_mul_f32 v[28:29], v[28:29], v[14:15] op_sel_hi:[1,0]
    v_pk_mul_f32 v[30:31], v[30:31], v[14:15] op_sel_hi:[1,0]
    v_cvt_pk_bf16_f32 v16, v16, v17
    v_cvt_pk_bf16_f32 v17, v18, v19
    v_cvt_pk_bf16_f32 v18, v20, v21
    v_cvt_pk_bf16_f32 v19, v22, v23
    v_cvt_pk_bf16_f32 v20, v24, v25
    v_cvt_pk_bf16_f32 v21, v26, v27
    v_cvt_pk_bf16_f32 v22, v28, v29
    v_cvt_pk_bf16_f32 v23, v30, v31
    v_mov_b32 v14, v44
    v_mov_b32 v15, v44
    s_nop 1
    v_permlane32_swap_b32 v14, v15
    s_nop 1
    v_cvt_pk_bf16_f32 v15, v15, v15
    v_lshlrev_b32 v15, 16, v15
    v_add_f32 v15, 0x358637bd, v15
    v_cvt_pk_bf16_f32 v15, v15, v15
    v_lshlrev_b32 v15, 16, v15
    v_rcp_f32 v14, v15
    s_nop 0
    v_pk_mul_f32 v[32:33], v[32:33], v[14:15] op_sel_hi:[1,0]
    v_pk_mul_f32 v[34:35], v[34:35], v[14:15] op_sel_hi:[1,0]
    v_pk_mul_f32 v[36:37], v[36:37], v[14:15] op_sel_hi:[1,0]
    v_pk_mul_f32 v[38:39], v[38:39], v[14:15] op_sel_hi:[1,0]
    v_pk_mul_f32 v[40:41], v[40:41], v[14:15] op_sel_hi:[1,0]
    v_pk_mul_f32 v[42:43], v[42:43], v[14:15] op_sel_hi:[1,0]
    v_pk_mul_f32 v[44:45], v[44:45], v[14:15] op_sel_hi:[1,0]
    v_pk_mul_f32 v[46:47], v[46:47], v[14:15] op_sel_hi:[1,0]
    v_cvt_pk_bf16_f32 v32, v32, v33
    v_cvt_pk_bf16_f32 v33, v34, v35
    v_cvt_pk_bf16_f32 v34, v36, v37
    v_cvt_pk_bf16_f32 v35, v38, v39
    v_cvt_pk_bf16_f32 v36, v40, v41
    v_cvt_pk_bf16_f32 v37, v42, v43
    v_cvt_pk_bf16_f32 v38, v44, v45
    v_cvt_pk_bf16_f32 v39, v46, v47
    s_nop 1
    v_mfma_f32_32x32x16_bf16 a[0:15], a[64:67], v[16:19], 0
    v_mfma_f32_32x32x16_bf16 a[0:15], a[68:71], v[20:23], a[0:15]
    v_mfma_f32_32x32x16_bf16 a[16:31], a[72:75], v[16:19], 0
    v_mfma_f32_32x32x16_bf16 a[16:31], a[76:79], v[20:23], a[16:31]
    v_mfma_f32_32x32x16_bf16 a[32:47], a[64:67], v[32:35], 0
    v_mfma_f32_32x32x16_bf16 a[32:47], a[68:71], v[36:39], a[32:47]
    v_mfma_f32_32x32x16_bf16 a[48:63], a[72:75], v[32:35], 0
    v_mfma_f32_32x32x16_bf16 a[48:63], a[76:79], v[36:39], a[48:63]
    s_waitcnt vmcnt(8)
    v_cvt_pk_bf16_f32 v48, v48, v49
    v_cvt_pk_bf16_f32 v49, v50, v51
    v_cvt_pk_bf16_f32 v52, v52, v53
    v_cvt_pk_bf16_f32 v53, v54, v55
    v_cvt_pk_bf16_f32 v56, v56, v57
    v_cvt_pk_bf16_f32 v57, v58, v59
    v_cvt_pk_bf16_f32 v60, v60, v61
    v_cvt_pk_bf16_f32 v61, v62, v63
    v_cvt_pk_bf16_f32 v64, v64, v65
    v_cvt_pk_bf16_f32 v65, v66, v67
    v_cvt_pk_bf16_f32 v68, v68, v69
    v_cvt_pk_bf16_f32 v69, v70, v71
    v_cvt_pk_bf16_f32 v72, v72, v73
    v_cvt_pk_bf16_f32 v73, v74, v75
    v_cvt_pk_bf16_f32 v76, v76, v77
    v_cvt_pk_bf16_f32 v77, v78, v79
    ds_write_b64 v8, v[48:49] offset:4352
    ds_write_b64 v8, v[52:53] offset:4896
    ds_write_b64 v8, v[56:57] offset:5440
    ds_write_b64 v8, v[60:61] offset:5984
    ds_write_b64 v8, v[64:65] offset:6528
    ds_write_b64 v8, v[68:69] offset:7072
    ds_write_b64 v8, v[72:73] offset:7616
    ds_write_b64 v8, v[76:77] offset:8160
    s_waitcnt lgkmcnt(0)
    ds_read_b64 v[144:145], v12 offset:4352
    ds_read_b64 v[146:147], v12 offset:4368
    ds_read_b64 v[148:149], v12 offset:4384
    ds_read_b64 v[150:151], v12 offset:4400
    ds_read_b64 v[152:153], v12 offset:4416
    ds_read_b64 v[154:155], v12 offset:4432
    ds_read_b64 v[156:157], v12 offset:4448
    ds_read_b64 v[158:159], v12 offset:4464
    s_waitcnt vmcnt(0) lgkmcnt(0)
    v_mfma_f32_32x32x16_bf16 v[48:63], v[144:147], v[112:115], 0
    v_mfma_f32_32x32x16_bf16 v[48:63], v[148:151], v[116:119], v[48:63]
    v_mfma_f32_32x32x16_bf16 v[48:63], v[152:155], v[120:123], v[48:63]
    v_mfma_f32_32x32x16_bf16 v[48:63], v[156:159], v[124:127], v[48:63]
    v_mfma_f32_32x32x16_bf16 v[64:79], v[144:147], v[128:131], 0
    v_mfma_f32_32x32x16_bf16 v[64:79], v[148:151], v[132:135], v[64:79]
    v_mfma_f32_32x32x16_bf16 v[64:79], v[152:155], v[136:139], v[64:79]
    v_mfma_f32_32x32x16_bf16 v[64:79], v[156:159], v[140:143], v[64:79]
    s_nop 13
    v_mov_b32 v14, v60
    v_mov_b32 v15, v60
    s_nop 1
    v_permlane32_swap_b32 v14, v15
    s_nop 1
    v_cvt_pk_bf16_f32 v15, v15, v15
    v_lshlrev_b32 v15, 16, v15
    v_add_f32 v15, 0x358637bd, v15
    v_cvt_pk_bf16_f32 v15, v15, v15
    v_lshlrev_b32 v15, 16, v15
    v_rcp_f32 v14, v15
    s_nop 0
    v_pk_mul_f32 v[48:49], v[48:49], v[14:15] op_sel_hi:[1,0]
    v_pk_mul_f32 v[50:51], v[50:51], v[14:15] op_sel_hi:[1,0]
    v_pk_mul_f32 v[52:53], v[52:53], v[14:15] op_sel_hi:[1,0]
    v_pk_mul_f32 v[54:55], v[54:55], v[14:15] op_sel_hi:[1,0]
    v_pk_mul_f32 v[56:57], v[56:57], v[14:15] op_sel_hi:[1,0]
    v_pk_mul_f32 v[58:59], v[58:59], v[14:15] op_sel_hi:[1,0]
    v_pk_mul_f32 v[60:61], v[60:61], v[14:15] op_sel_hi:[1,0]
    v_pk_mul_f32 v[62:63], v[62:63], v[14:15] op_sel_hi:[1,0]
    v_cvt_pk_bf16_f32 v48, v48, v49
    v_cvt_pk_bf16_f32 v49, v50, v51
    v_cvt_pk_bf16_f32 v50, v52, v53
    v_cvt_pk_bf16_f32 v51, v54, v55
    v_cvt_pk_bf16_f32 v52, v56, v57
    v_cvt_pk_bf16_f32 v53, v58, v59
    v_cvt_pk_bf16_f32 v54, v60, v61
    v_cvt_pk_bf16_f32 v55, v62, v63
    v_mov_b32 v14, v76
    v_mov_b32 v15, v76
    s_nop 1
    v_permlane32_swap_b32 v14, v15
    s_nop 1
    v_cvt_pk_bf16_f32 v15, v15, v15
    v_lshlrev_b32 v15, 16, v15
    v_add_f32 v15, 0x358637bd, v15
    v_cvt_pk_bf16_f32 v15, v15, v15
    v_lshlrev_b32 v15, 16, v15
    v_rcp_f32 v14, v15
    s_nop 0
    v_pk_mul_f32 v[64:65], v[64:65], v[14:15] op_sel_hi:[1,0]
    v_pk_mul_f32 v[66:67], v[66:67], v[14:15] op_sel_hi:[1,0]
    v_pk_mul_f32 v[68:69], v[68:69], v[14:15] op_sel_hi:[1,0]
    v_pk_mul_f32 v[70:71], v[70:71], v[14:15] op_sel_hi:[1,0]
    v_pk_mul_f32 v[72:73], v[72:73], v[14:15] op_sel_hi:[1,0]
    v_pk_mul_f32 v[74:75], v[74:75], v[14:15] op_sel_hi:[1,0]
    v_pk_mul_f32 v[76:77], v[76:77], v[14:15] op_sel_hi:[1,0]
    v_pk_mul_f32 v[78:79], v[78:79], v[14:15] op_sel_hi:[1,0]
    v_cvt_pk_bf16_f32 v64, v64, v65
    v_cvt_pk_bf16_f32 v65, v66, v67
    v_cvt_pk_bf16_f32 v66, v68, v69
    v_cvt_pk_bf16_f32 v67, v70, v71
    v_cvt_pk_bf16_f32 v68, v72, v73
    v_cvt_pk_bf16_f32 v69, v74, v75
    v_cvt_pk_bf16_f32 v70, v76, v77
    v_cvt_pk_bf16_f32 v71, v78, v79
    s_nop 1
    v_mfma_f32_32x32x16_bf16 a[0:15], a[80:83], v[48:51], a[0:15]
    v_mfma_f32_32x32x16_bf16 a[0:15], a[84:87], v[52:55], a[0:15]
    v_mfma_f32_32x32x16_bf16 a[16:31], a[88:91], v[48:51], a[16:31]
    v_mfma_f32_32x32x16_bf16 a[16:31], a[92:95], v[52:55], a[16:31]
    v_mfma_f32_32x32x16_bf16 a[32:47], a[80:83], v[64:67], a[32:47]
    v_mfma_f32_32x32x16_bf16 a[32:47], a[84:87], v[68:71], a[32:47]
    v_mfma_f32_32x32x16_bf16 a[48:63], a[88:91], v[64:67], a[48:63]
    v_mfma_f32_32x32x16_bf16 a[48:63], a[92:95], v[68:71], a[48:63]
    s_barrier
    s_nop 11
    s_lshr_b32 s54, s71, 1
    s_lshl_b32 s57, s52, 14
    v_add_u32 v12, s57, v1
    ds_write_b128 v12, a[0:3] offset:0
    ds_write_b128 v12, a[4:7] offset:1024
    ds_write_b128 v12, a[8:11] offset:2048
    ds_write_b128 v12, a[12:15] offset:3072
    ds_write_b128 v12, a[16:19] offset:4096
    ds_write_b128 v12, a[20:23] offset:5120
    ds_write_b128 v12, a[24:27] offset:6144
    ds_write_b128 v12, a[28:31] offset:7168
    ds_write_b128 v12, a[32:35] offset:8192
    ds_write_b128 v12, a[36:39] offset:9216
    ds_write_b128 v12, a[40:43] offset:10240
    ds_write_b128 v12, a[44:47] offset:11264
    ds_write_b128 v12, a[48:51] offset:12288
    ds_write_b128 v12, a[52:55] offset:13312
    ds_write_b128 v12, a[56:59] offset:14336
    ds_write_b128 v12, a[60:63] offset:15360
    s_waitcnt lgkmcnt(0)
    s_barrier
    s_cmp_ge_u32 s52, 4
    s_cbranch_scc1 EP5_N
    s_add_u32 s57, s63, s80
    buffer_load_dwordx4 v[144:147], v13, s[28:31], s57 offen
    buffer_load_dwordx4 v[148:151], v13, s[28:31], s57 offen offset:512
    s_lshl_b32 s57, s52, 12
    v_add_u32 v12, s57, v1
    v_add_u32 v14, 0x10000, v12
    ds_read_b128 v[16:19], v12 offset:0
    ds_read_b128 v[20:23], v12 offset:1024
    ds_read_b128 v[24:27], v12 offset:2048
    ds_read_b128 v[28:31], v12 offset:3072
    ds_read_b128 v[32:35], v12 offset:16384
    ds_read_b128 v[36:39], v12 offset:17408
    ds_read_b128 v[40:43], v12 offset:18432
    ds_read_b128 v[44:47], v12 offset:19456
    ds_read_b128 v[48:51], v12 offset:32768
    ds_read_b128 v[52:55], v12 offset:33792
    ds_read_b128 v[56:59], v12 offset:34816
    ds_read_b128 v[60:63], v12 offset:35840
    ds_read_b128 v[64:67], v12 offset:49152
    ds_read_b128 v[68:71], v12 offset:50176
    ds_read_b128 v[72:75], v12 offset:51200
    ds_read_b128 v[76:79], v12 offset:52224
    ds_read_b128 v[80:83], v14 offset:0
    ds_read_b128 v[84:87], v14 offset:1024
    ds_read_b128 v[88:91], v14 offset:2048
    ds_read_b128 v[92:95], v14 offset:3072
    ds_read_b128 v[96:99], v14 offset:16384
    ds_read_b128 v[100:103], v14 offset:17408
    ds_read_b128 v[104:107], v14 offset:18432
    ds_read_b128 v[108:111], v14 offset:19456
    ds_read_b128 v[112:115], v14 offset:32768
    ds_read_b128 v[116:119], v14 offset:33792
    ds_read_b128 v[120:123], v14 offset:34816
    ds_read_b128 v[124:127], v14 offset:35840
    ds_read_b128 v[128:131], v14 offset:49152
    ds_read_b128 v[132:135], v14 offset:50176
    ds_read_b128 v[136:139], v14 offset:51200
    ds_read_b128 v[140:143], v14 offset:52224
    s_waitcnt vmcnt(0) lgkmcnt(0)
    v_pk_add_f32 v[16:17], v[16:17], v[80:81]
    v_pk_add_f32 v[18:19], v[18:19], v[82:83]
    v_pk_add_f32 v[20:21], v[20:21], v[84:85]
    v_pk_add_f32 v[22:23], v[22:23], v[86:87]
    v_pk_add_f32 v[24:25], v[24:25], v[88:89]
    v_pk_add_f32 v[26:27], v[26:27], v[90:91]
    v_pk_add_f32 v[28:29], v[28:29], v[92:93]
    v_pk_add_f32 v[30:31], v[30:31], v[94:95]
    v_pk_add_f32 v[32:33], v[32:33], v[96:97]
    v_pk_add_f32 v[34:35], v[34:35], v[98:99]
    v_pk_add_f32 v[36:37], v[36:37], v[100:101]
    v_pk_add_f32 v[38:39], v[38:39], v[102:103]
    v_pk_add_f32 v[40:41], v[40:41], v[104:105]
    v_pk_add_f32 v[42:43], v[42:43], v[106:107]
    v_pk_add_f32 v[44:45], v[44:45], v[108:109]
    v_pk_add_f32 v[46:47], v[46:47], v[110:111]
    v_pk_add_f32 v[48:49], v[48:49], v[112:113]
    v_pk_add_f32 v[50:51], v[50:51], v[114:115]
    v_pk_add_f32 v[52:53], v[52:53], v[116:117]
    v_pk_add_f32 v[54:55], v[54:55], v[118:119]
    v_pk_add_f32 v[56:57], v[56:57], v[120:121]
    v_pk_add_f32 v[58:59], v[58:59], v[122:123]
    v_pk_add_f32 v[60:61], v[60:61], v[124:125]
    v_pk_add_f32 v[62:63], v[62:63], v[126:127]
    v_pk_add_f32 v[64:65], v[64:65], v[128:129]
    v_pk_add_f32 v[66:67], v[66:67], v[130:131]
    v_pk_add_f32 v[68:69], v[68:69], v[132:133]
    v_pk_add_f32 v[70:71], v[70:71], v[134:135]
    v_pk_add_f32 v[72:73], v[72:73], v[136:137]
    v_pk_add_f32 v[74:75], v[74:75], v[138:139]
    v_pk_add_f32 v[76:77], v[76:77], v[140:141]
    v_pk_add_f32 v[78:79], v[78:79], v[142:143]
    v_pk_add_f32 v[16:17], v[16:17], v[48:49]
    v_pk_add_f32 v[18:19], v[18:19], v[50:51]
    v_pk_add_f32 v[20:21], v[20:21], v[52:53]
    v_pk_add_f32 v[22:23], v[22:23], v[54:55]
    v_pk_add_f32 v[24:25], v[24:25], v[56:57]
    v_pk_add_f32 v[26:27], v[26:27], v[58:59]
    v_pk_add_f32 v[28:29], v[28:29], v[60:61]
    v_pk_add_f32 v[30:31], v[30:31], v[62:63]
    v_pk_add_f32 v[32:33], v[32:33], v[64:65]
    v_pk_add_f32 v[34:35], v[34:35], v[66:67]
    v_pk_add_f32 v[36:37], v[36:37], v[68:69]
    v_pk_add_f32 v[38:39], v[38:39], v[70:71]
    v_pk_add_f32 v[40:41], v[40:41], v[72:73]
    v_pk_add_f32 v[42:43], v[42:43], v[74:75]
    v_pk_add_f32 v[44:45], v[44:45], v[76:77]
    v_pk_add_f32 v[46:47], v[46:47], v[78:79]
    v_pk_add_f32 v[16:17], v[16:17], v[32:33]
    v_pk_add_f32 v[18:19], v[18:19], v[34:35]
    v_pk_add_f32 v[20:21], v[20:21], v[36:37]
    v_pk_add_f32 v[22:23], v[22:23], v[38:39]
    v_pk_add_f32 v[24:25], v[24:25], v[40:41]
    v_pk_add_f32 v[26:27], v[26:27], v[42:43]
    v_pk_add_f32 v[28:29], v[28:29], v[44:45]
    v_pk_add_f32 v[30:31], v[30:31], v[46:47]
    v_cvt_pk_bf16_f32 v32, v16, v17
    v_cvt_pk_bf16_f32 v33, v18, v19
    v_cvt_pk_bf16_f32 v34, v20, v21
    v_cvt_pk_bf16_f32 v35, v22, v23
    v_cvt_pk_bf16_f32 v36, v24, v25
    v_cvt_pk_bf16_f32 v37, v26, v27
    v_cvt_pk_bf16_f32 v38, v28, v29
    v_cvt_pk_bf16_f32 v39, v30, v31
    v_lshlrev_b32 v16, 16, v32
    v_and_b32 v17, 0xffff0000, v32
    v_lshlrev_b32 v48, 16, v144
    v_and_b32 v49, 0xffff0000, v144
    v_lshlrev_b32 v18, 16, v33
    v_and_b32 v19, 0xffff0000, v33
    v_lshlrev_b32 v50, 16, v145
    v_and_b32 v51, 0xffff0000, v145
    v_lshlrev_b32 v20, 16, v34
    v_and_b32 v21, 0xffff0000, v34
    v_lshlrev_b32 v52, 16, v146
    v_and_b32 v53, 0xffff0000, v146
    v_lshlrev_b32 v22, 16, v35
    v_and_b32 v23, 0xffff0000, v35
    v_lshlrev_b32 v54, 16, v147
    v_and_b32 v55, 0xffff0000, v147
    v_lshlrev_b32 v24, 16, v36
    v_and_b32 v25, 0xffff0000, v36
    v_lshlrev_b32 v56, 16, v148
    v_and_b32 v57, 0xffff0000, v148
    v_lshlrev_b32 v26, 16, v37
    v_and_b32 v27, 0xffff0000, v37
    v_lshlrev_b32 v58, 16, v149
    v_and_b32 v59, 0xffff0000, v149
    v_lshlrev_b32 v28, 16, v38
    v_and_b32 v29, 0xffff0000, v38
    v_lshlrev_b32 v60, 16, v150
    v_and_b32 v61, 0xffff0000, v150
    v_lshlrev_b32 v30, 16, v39
    v_and_b32 v31, 0xffff0000, v39
    v_lshlrev_b32 v62, 16, v151
    v_and_b32 v63, 0xffff0000, v151
    v_pk_add_f32 v[16:17], v[16:17], v[48:49]
    v_pk_add_f32 v[18:19], v[18:19], v[50:51]
    v_pk_add_f32 v[20:21], v[20:21], v[52:53]
    v_pk_add_f32 v[22:23], v[22:23], v[54:55]
    v_pk_add_f32 v[24:25], v[24:25], v[56:57]
    v_pk_add_f32 v[26:27], v[26:27], v[58:59]
    v_pk_add_f32 v[28:29], v[28:29], v[60:61]
    v_pk_add_f32 v[30:31], v[30:31], v[62:63]
    v_cvt_pk_bf16_f32 v32, v16, v17
    v_cvt_pk_bf16_f32 v33, v18, v19
    v_cvt_pk_bf16_f32 v34, v20, v21
    v_cvt_pk_bf16_f32 v35, v22, v23
    v_cvt_pk_bf16_f32 v36, v24, v25
    v_cvt_pk_bf16_f32 v37, v26, v27
    v_cvt_pk_bf16_f32 v38, v28, v29
    v_cvt_pk_bf16_f32 v39, v30, v31
    s_add_u32 s57, s63, s81
    buffer_store_dwordx4 v[32:35], v13, s[28:31], s57 offen sc1
    buffer_store_dwordx4 v[36:39], v13, s[28:31], s57 offen offset:512 sc1
    v_lshlrev_b32 v16, 16, v32
    v_and_b32 v17, 0xffff0000, v32
    v_lshlrev_b32 v18, 16, v33
    v_and_b32 v19, 0xffff0000, v33
    v_lshlrev_b32 v20, 16, v34
    v_and_b32 v21, 0xffff0000, v34
    v_lshlrev_b32 v22, 16, v35
    v_and_b32 v23, 0xffff0000, v35
    v_lshlrev_b32 v24, 16, v36
    v_and_b32 v25, 0xffff0000, v36
    v_lshlrev_b32 v26, 16, v37
    v_and_b32 v27, 0xffff0000, v37
    v_lshlrev_b32 v28, 16, v38
    v_and_b32 v29, 0xffff0000, v38
    v_lshlrev_b32 v30, 16, v39
    v_and_b32 v31, 0xffff0000, v39
    v_pk_mul_f32 v[50:51], v[16:17], v[16:17]
    v_pk_add_f32 v[48:49], v[16:17], v[18:19]
    v_pk_fma_f32 v[50:51], v[18:19], v[18:19], v[50:51]
    v_pk_add_f32 v[48:49], v[48:49], v[20:21]
    v_pk_fma_f32 v[50:51], v[20:21], v[20:21], v[50:51]
    v_pk_add_f32 v[48:49], v[48:49], v[22:23]
    v_pk_fma_f32 v[50:51], v[22:23], v[22:23], v[50:51]
    v_pk_add_f32 v[48:49], v[48:49], v[24:25]
    v_pk_fma_f32 v[50:51], v[24:25], v[24:25], v[50:51]
    v_pk_add_f32 v[48:49], v[48:49], v[26:27]
    v_pk_fma_f32 v[50:51], v[26:27], v[26:27], v[50:51]
    v_pk_add_f32 v[48:49], v[48:49], v[28:29]
    v_pk_fma_f32 v[50:51], v[28:29], v[28:29], v[50:51]
    v_pk_add_f32 v[48:49], v[48:49], v[30:31]
    v_pk_fma_f32 v[50:51], v[30:31], v[30:31], v[50:51]
    v_add_f32 v48, v48, v49
    v_add_f32 v49, v50, v51
    s_nop 1
    v_permlane32_swap_b32 v48, v49
    s_nop 1
    v_add_f32 v48, v48, v49
    s_lshl_b32 s57, s62, 8
    s_add_u32 s57, s57, s87
    v_lshlrev_b32 v12, 3, v10
    v_lshl_add_u32 v12, v11, 2, v12
    buffer_atomic_add_f32 v48, v12, s[28:31], s57 offen
    s_waitcnt vmcnt(0) lgkmcnt(0)
    s_barrier
    s_cmp_lg_u32 s52, 0
    s_cbranch_scc1 EP5_S
    s_lshl_b32 s57, s54, 7
    s_add_u32 s57, s57, s90
    v_mov_b32 v3, 1
    v_mov_b32 v9, 0
    s_mov_b64 exec, 1
    buffer_atomic_add v3, v9, s[28:31], s57 offen sc1
    s_mov_b64 exec, -1
EP5_S:
    s_lshl_b32 s55, s72, 2
    s_add_u32 s55, s55, s75
    s_mul_i32 s56, s55, 57344
    s_add_u32 s56, s56, 1867776
    s_add_u32 s57, s56, 0
    buffer_load_dwordx4 a[0:3], v1, s[28:31], s57 offen offset:0
    buffer_load_dwordx4 a[4:7], v1, s[28:31], s57 offen offset:1024
    s_add_u32 s57, s56, 0
    buffer_load_dwordx4 a[8:11], v1, s[28:31], s57 offen offset:2048
    buffer_load_dwordx4 a[12:15], v1, s[28:31], s57 offen offset:3072
    s_add_u32 s57, s56, 4096
    buffer_load_dwordx4 a[16:19], v1, s[28:31], s57 offen offset:0
    buffer_load_dwordx4 a[20:23], v1, s[28:31], s57 offen offset:1024
    s_add_u32 s57, s56, 4096
    buffer_load_dwordx4 a[24:27], v1, s[28:31], s57 offen offset:2048
    buffer_load_dwordx4 a[28:31], v1, s[28:31], s57 offen offset:3072
    s_add_u32 s57, s56, 8192
    buffer_load_dwordx4 a[32:35], v1, s[28:31], s57 offen offset:0
    buffer_load_dwordx4 a[36:39], v1, s[28:31], s57 offen offset:1024
    s_add_u32 s57, s56, 8192
    buffer_load_dwordx4 a[40:43], v1, s[28:31], s57 offen offset:2048
    buffer_load_dwordx4 a[44:47], v1, s[28:31], s57 offen offset:3072
    s_add_u32 s57, s56, 12288
    buffer_load_dwordx4 a[48:51], v1, s[28:31], s57 offen offset:0
    buffer_load_dwordx4 a[52:55], v1, s[28:31], s57 offen offset:1024
    s_add_u32 s57, s56, 12288
    buffer_load_dwordx4 a[56:59], v1, s[28:31], s57 offen offset:2048
    buffer_load_dwordx4 a[60:63], v1, s[28:31], s57 offen offset:3072
    s_add_u32 s57, s56, 16384
    buffer_load_dwordx4 a[64:67], v1, s[28:31], s57 offen offset:0
    buffer_load_dwordx4 a[68:71], v1, s[28:31], s57 offen offset:1024
    s_add_u32 s57, s56, 16384
    buffer_load_dwordx4 a[72:75], v1, s[28:31], s57 offen offset:2048
    buffer_load_dwordx4 a[76:79], v1, s[28:31], s57 offen offset:3072
    s_add_u32 s57, s56, 20480
    buffer_load_dwordx4 a[80:83], v1, s[28:31], s57 offen offset:0
    buffer_load_dwordx4 a[84:87], v1, s[28:31], s57 offen offset:1024
    s_add_u32 s57, s56, 20480
    buffer_load_dwordx4 a[88:91], v1, s[28:31], s57 offen offset:2048
    buffer_load_dwordx4 a[92:95], v1, s[28:31], s57 offen offset:3072
    s_lshl_b32 s57, s55, 8
    s_add_u32 s57, s57, 7299072
    v_lshlrev_b32 v12, 4, v11
    buffer_load_dwordx4 v[32:35], v12, s[28:31], s57 offen offset:0
    buffer_load_dwordx4 v[36:39], v12, s[28:31], s57 offen offset:32
    buffer_load_dwordx4 v[40:43], v12, s[28:31], s57 offen offset:64
    buffer_load_dwordx4 v[44:47], v12, s[28:31], s57 offen offset:96
    buffer_load_dwordx4 v[48:51], v12, s[28:31], s57 offen offset:128
    buffer_load_dwordx4 v[52:55], v12, s[28:31], s57 offen offset:160
    buffer_load_dwordx4 v[56:59], v12, s[28:31], s57 offen offset:192
    buffer_load_dwordx4 v[60:63], v12, s[28:31], s57 offen offset:224
    s_branch EP5_E
EP5_N:
    s_lshl_b32 s55, s72, 2
    s_add_u32 s55, s55, s75
    s_mul_i32 s56, s55, 57344
    s_add_u32 s56, s56, 1867776
    s_add_u32 s57, s56, 0
    buffer_load_dwordx4 a[0:3], v1, s[28:31], s57 offen offset:0
    buffer_load_dwordx4 a[4:7], v1, s[28:31], s57 offen offset:1024
    s_add_u32 s57, s56, 0
    buffer_load_dwordx4 a[8:11], v1, s[28:31], s57 offen offset:2048
    buffer_load_dwordx4 a[12:15], v1, s[28:31], s57 offen offset:3072
    s_add_u32 s57, s56, 4096
    buffer_load_dwordx4 a[16:19], v1, s[28:31], s57 offen offset:0
    buffer_load_dwordx4 a[20:23], v1, s[28:31], s57 offen offset:1024
    s_add_u32 s57, s56, 4096
    buffer_load_dwordx4 a[24:27], v1, s[28:31], s57 offen offset:2048
    buffer_load_dwordx4 a[28:31], v1, s[28:31], s57 offen offset:3072
    s_add_u32 s57, s56, 8192
    buffer_load_dwordx4 a[32:35], v1, s[28:31], s57 offen offset:0
    buffer_load_dwordx4 a[36:39], v1, s[28:31], s57 offen offset:1024
    s_add_u32 s57, s56, 8192
    buffer_load_dwordx4 a[40:43], v1, s[28:31], s57 offen offset:2048
    buffer_load_dwordx4 a[44:47], v1, s[28:31], s57 offen offset:3072
    s_add_u32 s57, s56, 12288
    buffer_load_dwordx4 a[48:51], v1, s[28:31], s57 offen offset:0
    buffer_load_dwordx4 a[52:55], v1, s[28:31], s57 offen offset:1024
    s_add_u32 s57, s56, 12288
    buffer_load_dwordx4 a[56:59], v1, s[28:31], s57 offen offset:2048
    buffer_load_dwordx4 a[60:63], v1, s[28:31], s57 offen offset:3072
    s_add_u32 s57, s56, 16384
    buffer_load_dwordx4 a[64:67], v1, s[28:31], s57 offen offset:0
    buffer_load_dwordx4 a[68:71], v1, s[28:31], s57 offen offset:1024
    s_add_u32 s57, s56, 16384
    buffer_load_dwordx4 a[72:75], v1, s[28:31], s57 offen offset:2048
    buffer_load_dwordx4 a[76:79], v1, s[28:31], s57 offen offset:3072
    s_add_u32 s57, s56, 20480
    buffer_load_dwordx4 a[80:83], v1, s[28:31], s57 offen offset:0
    buffer_load_dwordx4 a[84:87], v1, s[28:31], s57 offen offset:1024
    s_add_u32 s57, s56, 20480
    buffer_load_dwordx4 a[88:91], v1, s[28:31], s57 offen offset:2048
    buffer_load_dwordx4 a[92:95], v1, s[28:31], s57 offen offset:3072
    s_lshl_b32 s57, s55, 8
    s_add_u32 s57, s57, 7299072
    v_lshlrev_b32 v12, 4, v11
    buffer_load_dwordx4 v[32:35], v12, s[28:31], s57 offen offset:0
    buffer_load_dwordx4 v[36:39], v12, s[28:31], s57 offen offset:32
    buffer_load_dwordx4 v[40:43], v12, s[28:31], s57 offen offset:64
    buffer_load_dwordx4 v[44:47], v12, s[28:31], s57 offen offset:96
    buffer_load_dwordx4 v[48:51], v12, s[28:31], s57 offen offset:128
    buffer_load_dwordx4 v[52:55], v12, s[28:31], s57 offen offset:160
    buffer_load_dwordx4 v[56:59], v12, s[28:31], s57 offen offset:192
    buffer_load_dwordx4 v[60:63], v12, s[28:31], s57 offen offset:224
    s_barrier
EP5_E:
    s_cmp_lg_u32 s52, 0
    s_cbranch_scc1 WT6_P
    s_lshl_b32 s57, s73, 7
    s_add_u32 s57, s57, s90
    v_lshlrev_b32 v9, 7, v2
    s_mov_b64 exec, 1
    s_mov_b32 s58, 0
WT6_L:
    buffer_load_dword v3, v9, s[28:31], s57 offen sc1
    s_waitcnt vmcnt(0)
    v_cmp_gt_u32 vcc, 14, v3
    s_add_u32 s58, s58, 1
    s_cmp_eq_u64 vcc, 0
    s_cbranch_scc1 WT6_E
    s_sleep 1
    s_cmp_lt_u32 s58, 0x40000
    s_cbranch_scc1 WT6_L
WT6_E:
    s_mov_b64 exec, -1
    s_barrier
    s_branch WT6_D
WT6_P:
    s_barrier
WT6_D:
    s_mul_i32 s58, s73, 114688
    s_add_u32 s65, s58, s81
    s_mul_i32 s58, s52, 14336
    s_add_u32 s65, s65, s58
    s_add_u32 m0, s58, 0
    s_add_u32 s59, s65, 0
    buffer_load_dwordx4 v1, s[28:31], s59 offen offset:0 lds
    buffer_load_dwordx4 v1, s[28:31], s59 offen offset:1024 lds
    buffer_load_dwordx4 v1, s[28:31], s59 offen offset:2048 lds
    buffer_load_dwordx4 v1, s[28:31], s59 offen offset:3072 lds
    s_add_u32 m0, s58, 4096
    s_add_u32 s59, s65, 4096
    buffer_load_dwordx4 v1, s[28:31], s59 offen offset:0 lds
    buffer_load_dwordx4 v1, s[28:31], s59 offen offset:1024 lds
    buffer_load_dwordx4 v1, s[28:31], s59 offen offset:2048 lds
    buffer_load_dwordx4 v1, s[28:31], s59 offen offset:3072 lds
    s_add_u32 m0, s58, 8192
    s_add_u32 s59, s65, 8192
    buffer_load_dwordx4 v1, s[28:31], s59 offen offset:0 lds
    buffer_load_dwordx4 v1, s[28:31], s59 offen offset:1024 lds
    buffer_load_dwordx4 v1, s[28:31], s59 offen offset:2048 lds
    buffer_load_dwordx4 v1, s[28:31], s59 offen offset:3072 lds
    s_add_u32 m0, s58, 12288
    s_add_u32 s59, s65, 12288
    buffer_load_dwordx4 v1, s[28:31], s59 offen offset:0 lds
    buffer_load_dwordx4 v1, s[28:31], s59 offen offset:1024 lds
    s_lshl_b32 s57, s73, 10
    s_lshl_b32 s58, s76, 9
    s_add_u32 s57, s57, s58
    s_add_u32 s57, s57, s87
    v_lshlrev_b32 v12, 3, v10
    buffer_load_dwordx2 v[4:5], v12, s[28:31], s57 offen offset:0
    buffer_load_dwordx2 v[6:7], v12, s[28:31], s57 offen offset:256
    s_mul_i32 s57, s76, 57344
    v_add_u32 v8, s57, v1
    s_waitcnt vmcnt(2)
    s_barrier
    ds_read_b128 v[16:19], v8 offset:0
    ds_read_b128 v[20:23], v8 offset:28672
    ds_read_b128 v[24:27], v8 offset:1024
    ds_read_b128 v[28:31], v8 offset:29696
    s_waitcnt lgkmcnt(2)
    v_mfma_f32_32x32x16_bf16 v[64:79], a[0:3], v[16:19], 0
    v_mfma_f32_32x32x16_bf16 v[80:95], a[4:7], v[16:19], 0
    v_mfma_f32_32x32x16_bf16 v[96:111], a[0:3], v[20:23], 0
    v_mfma_f32_32x32x16_bf16 v[112:127], a[4:7], v[20:23], 0
    s_add_u32 s57, s56, 24576
    buffer_load_dwordx4 a[0:3], v1, s[28:31], s57 offen offset:0
    buffer_load_dwordx4 a[4:7], v1, s[28:31], s57 offen offset:1024
    ds_read_b128 v[16:19], v8 offset:2048
    ds_read_b128 v[20:23], v8 offset:30720
    s_waitcnt lgkmcnt(2)
    v_mfma_f32_32x32x16_bf16 v[64:79], a[8:11], v[24:27], v[64:79]
    v_mfma_f32_32x32x16_bf16 v[80:95], a[12:15], v[24:27], v[80:95]
    v_mfma_f32_32x32x16_bf16 v[96:111], a[8:11], v[28:31], v[96:111]
    v_mfma_f32_32x32x16_bf16 v[112:127], a[12:15], v[28:31], v[112:127]
    s_add_u32 s57, s56, 24576
    buffer_load_dwordx4 a[8:11], v1, s[28:31], s57 offen offset:2048
    buffer_load_dwordx4 a[12:15], v1, s[28:31], s57 offen offset:3072
    ds_read_b128 v[24:27], v8 offset:3072
    ds_read_b128 v[28:31], v8 offset:31744
    s_waitcnt lgkmcnt(2)
    v_mfma_f32_32x32x16_bf16 v[64:79], a[16:19], v[16:19], v[64:79]
    v_mfma_f32_32x32x16_bf16 v[80:95], a[20:23], v[16:19], v[80:95]
    v_mfma_f32_32x32x16_bf16 v[96:111], a[16:19], v[20:23], v[96:111]
    v_mfma_f32_32x32x16_bf16 v[112:127], a[20:23], v[20:23], v[112:127]
    s_add_u32 s57, s56, 28672
    buffer_load_dwordx4 a[16:19], v1, s[28:31], s57 offen offset:0
    buffer_load_dwordx4 a[20:23], v1, s[28:31], s57 offen offset:1024
    ds_read_b128 v[16:19], v8 offset:4096
    ds_read_b128 v[20:23], v8 offset:32768
    s_waitcnt lgkmcnt(2)
    v_mfma_f32_32x32x16_bf16 v[64:79], a[24:27], v[24:27], v[64:79]
    v_mfma_f32_32x32x16_bf16 v[80:95], a[28:31], v[24:27], v[80:95]
    v_mfma_f32_32x32x16_bf16 v[96:111], a[24:27], v[28:31], v[96:111]
    v_mfma_f32_32x32x16_bf16 v[112:127], a[28:31], v[28:31], v[112:127]
    s_add_u32 s57, s56, 28672
    buffer_load_dwordx4 a[24:27], v1, s[28:31], s57 offen offset:2048
    buffer_load_dwordx4 a[28:31], v1, s[28:31], s57 offen offset:3072
    ds_read_b128 v[24:27], v8 offset:5120
    ds_read_b128 v[28:31], v8 offset:33792
    s_waitcnt lgkmcnt(2)
    v_mfma_f32_32x32x16_bf16 v[64:79], a[32:35], v[16:19], v[64:79]
    v_mfma_f32_32x32x16_bf16 v[80:95], a[36:39], v[16:19], v[80:95]
    v_mfma_f32_32x32x16_bf16 v[96:111], a[32:35], v[20:23], v[96:111]
    v_mfma_f32_32x32x16_bf16 v[112:127], a[36:39], v[20:23], v[112:127]
    s_add_u32 s57, s56, 32768
    buffer_load_dwordx4 a[32:35], v1, s[28:31], s57 offen offset:0
    buffer_load_dwordx4 a[36:39], v1, s[28:31], s57 offen offset:1024
    ds_read_b128 v[16:19], v8 offset:6144
    ds_read_b128 v[20:23], v8 offset:34816
    s_waitcnt lgkmcnt(2)
    v_mfma_f32_32x32x16_bf16 v[64:79], a[40:43], v[24:27], v[64:79]
    v_mfma_f32_32x32x16_bf16 v[80:95], a[44:47], v[24:27], v[80:95]
    v_mfma_f32_32x32x16_bf16 v[96:111], a[40:43], v[28:31], v[96:111]
    v_mfma_f32_32x32x16_bf16 v[112:127], a[44:47], v[28:31], v[112:127]
    s_add_u32 s57, s56, 32768
    buffer_load_dwordx4 a[40:43], v1, s[28:31], s57 offen offset:2048
    buffer_load_dwordx4 a[44:47], v1, s[28:31], s57 offen offset:3072
    ds_read_b128 v[24:27], v8 offset:7168
    ds_read_b128 v[28:31], v8 offset:35840
    s_waitcnt lgkmcnt(2)
    v_mfma_f32_32x32x16_bf16 v[64:79], a[48:51], v[16:19], v[64:79]
    v_mfma_f32_32x32x16_bf16 v[80:95], a[52:55], v[16:19], v[80:95]
    v_mfma_f32_32x32x16_bf16 v[96:111], a[48:51], v[20:23], v[96:111]
    v_mfma_f32_32x32x16_bf16 v[112:127], a[52:55], v[20:23], v[112:127]
    s_add_u32 s57, s56, 36864
    buffer_load_dwordx4 a[48:51], v1, s[28:31], s57 offen offset:0
    buffer_load_dwordx4 a[52:55], v1, s[28:31], s57 offen offset:1024
    ds_read_b128 v[16:19], v8 offset:8192
    ds_read_b128 v[20:23], v8 offset:36864
    s_waitcnt lgkmcnt(2)
    v_mfma_f32_32x32x16_bf16 v[64:79], a[56:59], v[24:27], v[64:79]
    v_mfma_f32_32x32x16_bf16 v[80:95], a[60:63], v[24:27], v[80:95]
    v_mfma_f32_32x32x16_bf16 v[96:111], a[56:59], v[28:31], v[96:111]
    v_mfma_f32_32x32x16_bf16 v[112:127], a[60:63], v[28:31], v[112:127]
    s_add_u32 s57, s56, 36864
    buffer_load_dwordx4 a[56:59], v1, s[28:31], s57 offen offset:2048
    buffer_load_dwordx4 a[60:63], v1, s[28:31], s57 offen offset:3072
    ds_read_b128 v[24:27], v8 offset:9216
    ds_read_b128 v[28:31], v8 offset:37888
    s_waitcnt lgkmcnt(2)
    v_mfma_f32_32x32x16_bf16 v[64:79], a[64:67], v[16:19], v[64:79]
    v_mfma_f32_32x32x16_bf16 v[80:95], a[68:71], v[16:19], v[80:95]
    v_mfma_f32_32x32x16_bf16 v[96:111], a[64:67], v[20:23], v[96:111]
    v_mfma_f32_32x32x16_bf16 v[112:127], a[68:71], v[20:23], v[112:127]
    s_add_u32 s57, s56, 40960
    buffer_load_dwordx4 a[64:67], v1, s[28:31], s57 offen offset:0
    buffer_load_dwordx4 a[68:71], v1, s[28:31], s57 offen offset:1024
    ds_read_b128 v[16:19], v8 offset:10240
    ds_read_b128 v[20:23], v8 offset:38912
    s_waitcnt lgkmcnt(2)
    v_mfma_f32_32x32x16_bf16 v[64:79], a[72:75], v[24:27], v[64:79]
    v_mfma_f32_32x32x16_bf16 v[80:95], a[76:79], v[24:27], v[80:95]
    v_mfma_f32_32x32x16_bf16 v[96:111], a[72:75], v[28:31], v[96:111]
    v_mfma_f32_32x32x16_bf16 v[112:127], a[76:79], v[28:31], v[112:127]
    s_add_u32 s57, s56, 40960
    buffer_load_dwordx4 a[72:75], v1, s[28:31], s57 offen offset:2048
    buffer_load_dwordx4 a[76:79], v1, s[28:31], s57 offen offset:3072
    ds_read_b128 v[24:27], v8 offset:11264
    ds_read_b128 v[28:31], v8 offset:39936
    s_waitcnt lgkmcnt(2)
    v_mfma_f32_32x32x16_bf16 v[64:79], a[80:83], v[16:19], v[64:79]
    v_mfma_f32_32x32x16_bf16 v[80:95], a[84:87], v[16:19], v[80:95]
    v_mfma_f32_32x32x16_bf16 v[96:111], a[80:83], v[20:23], v[96:111]
    v_mfma_f32_32x32x16_bf16 v[112:127], a[84:87], v[20:23], v[112:127]
    s_add_u32 s57, s56, 45056
    buffer_load_dwordx4 a[80:83], v1, s[28:31], s57 offen offset:0
    buffer_load_dwordx4 a[84:87], v1, s[28:31], s57 offen offset:1024
    ds_read_b128 v[16:19], v8 offset:12288
    ds_read_b128 v[20:23], v8 offset:40960
    s_waitcnt lgkmcnt(2)
    v_mfma_f32_32x32x16_bf16 v[64:79], a[88:91], v[24:27], v[64:79]
    v_mfma_f32_32x32x16_bf16 v[80:95], a[92:95], v[24:27], v[80:95]
    v_mfma_f32_32x32x16_bf16 v[96:111], a[88:91], v[28:31], v[96:111]
    v_mfma_f32_32x32x16_bf16 v[112:127], a[92:95], v[28:31], v[112:127]
    s_add_u32 s57, s56, 45056
    buffer_load_dwordx4 a[88:91], v1, s[28:31], s57 offen offset:2048
    buffer_load_dwordx4 a[92:95], v1, s[28:31], s57 offen offset:3072
    ds_read_b128 v[24:27], v8 offset:13312
    ds_read_b128 v[28:31], v8 offset:41984
    s_waitcnt vmcnt(22) lgkmcnt(2)
    v_mfma_f32_32x32x16_bf16 v[64:79], a[0:3], v[16:19], v[64:79]
    v_mfma_f32_32x32x16_bf16 v[80:95], a[4:7], v[16:19], v[80:95]
    v_mfma_f32_32x32x16_bf16 v[96:111], a[0:3], v[20:23], v[96:111]
    v_mfma_f32_32x32x16_bf16 v[112:127], a[4:7], v[20:23], v[112:127]
    s_add_u32 s57, s56, 49152
    buffer_load_dwordx4 a[0:3], v1, s[28:31], s57 offen offset:0
    buffer_load_dwordx4 a[4:7], v1, s[28:31], s57 offen offset:1024
    ds_read_b128 v[16:19], v8 offset:14336
    ds_read_b128 v[20:23], v8 offset:43008
    s_waitcnt vmcnt(22) lgkmcnt(2)
    v_mfma_f32_32x32x16_bf16 v[64:79], a[8:11], v[24:27], v[64:79]
    v_mfma_f32_32x32x16_bf16 v[80:95], a[12:15], v[24:27], v[80:95]
    v_mfma_f32_32x32x16_bf16 v[96:111], a[8:11], v[28:31], v[96:111]
    v_mfma_f32_32x32x16_bf16 v[112:127], a[12:15], v[28:31], v[112:127]
    s_add_u32 s57, s56, 49152
    buffer_load_dwordx4 a[8:11], v1, s[28:31], s57 offen offset:2048
    buffer_load_dwordx4 a[12:15], v1, s[28:31], s57 offen offset:3072
    ds_read_b128 v[24:27], v8 offset:15360
    ds_read_b128 v[28:31], v8 offset:44032
    s_waitcnt vmcnt(22) lgkmcnt(2)
    v_mfma_f32_32x32x16_bf16 v[64:79], a[16:19], v[16:19], v[64:79]
    v_mfma_f32_32x32x16_bf16 v[80:95], a[20:23], v[16:19], v[80:95]
    v_mfma_f32_32x32x16_bf16 v[96:111], a[16:19], v[20:23], v[96:111]
    v_mfma_f32_32x32x16_bf16 v[112:127], a[20:23], v[20:23], v[112:127]
    s_add_u32 s57, s56, 53248
    buffer_load_dwordx4 a[16:19], v1, s[28:31], s57 offen offset:0
    buffer_load_dwordx4 a[20:23], v1, s[28:31], s57 offen offset:1024
    ds_read_b128 v[16:19], v8 offset:16384
    ds_read_b128 v[20:23], v8 offset:45056
    s_waitcnt vmcnt(22) lgkmcnt(2)
    v_mfma_f32_32x32x16_bf16 v[64:79], a[24:27], v[24:27], v[64:79]
    v_mfma_f32_32x32x16_bf16 v[80:95], a[28:31], v[24:27], v[80:95]
    v_mfma_f32_32x32x16_bf16 v[96:111], a[24:27], v[28:31], v[96:111]
    v_mfma_f32_32x32x16_bf16 v[112:127], a[28:31], v[28:31], v[112:127]
    s_add_u32 s57, s56, 53248
    buffer_load_dwordx4 a[24:27], v1, s[28:31], s57 offen offset:2048
    buffer_load_dwordx4 a[28:31], v1, s[28:31], s57 offen offset:3072
    ds_read_b128 v[24:27], v8 offset:17408
    ds_read_b128 v[28:31], v8 offset:46080
    s_waitcnt vmcnt(22) lgkmcnt(2)
    v_mfma_f32_32x32x16_bf16 v[64:79], a[32:35], v[16:19], v[64:79]
    v_mfma_f32_32x32x16_bf16 v[80:95], a[36:39], v[16:19], v[80:95]
    v_mfma_f32_32x32x16_bf16 v[96:111], a[32:35], v[20:23], v[96:111]
    v_mfma_f32_32x32x16_bf16 v[112:127], a[36:39], v[20:23], v[112:127]
    ds_read_b128 v[16:19], v8 offset:18432
    ds_read_b128 v[20:23], v8 offset:47104
    s_waitcnt vmcnt(20) lgkmcnt(2)
    v_mfma_f32_32x32x16_bf16 v[64:79], a[40:43], v[24:27], v[64:79]
    v_mfma_f32_32x32x16_bf16 v[80:95], a[44:47], v[24:27], v[80:95]
    v_mfma_f32_32x32x16_bf16 v[96:111], a[40:43], v[28:31], v[96:111]
    v_mfma_f32_32x32x16_bf16 v[112:127], a[44:47], v[28:31], v[112:127]
    ds_read_b128 v[24:27], v8 offset:19456
    ds_read_b128 v[28:31], v8 offset:48128
    s_waitcnt vmcnt(18) lgkmcnt(2)
    v_mfma_f32_32x32x16_bf16 v[64:79], a[48:51], v[16:19], v[64:79]
    v_mfma_f32_32x32x16_bf16 v[80:95], a[52:55], v[16:19], v[80:95]
    v_mfma_f32_32x32x16_bf16 v[96:111], a[48:51], v[20:23], v[96:111]
    v_mfma_f32_32x32x16_bf16 v[112:127], a[52:55], v[20:23], v[112:127]
    ds_read_b128 v[16:19], v8 offset:20480
    ds_read_b128 v[20:23], v8 offset:49152
    s_waitcnt vmcnt(16) lgkmcnt(2)
    v_mfma_f32_32x32x16_bf16 v[64:79], a[56:59], v[24:27], v[64:79]
    v_mfma_f32_32x32x16_bf16 v[80:95], a[60:63], v[24:27], v[80:95]
    v_mfma_f32_32x32x16_bf16 v[96:111], a[56:59], v[28:31], v[96:111]
    v_mfma_f32_32x32x16_bf16 v[112:127], a[60:63], v[28:31], v[112:127]
    ds_read_b128 v[24:27], v8 offset:21504
    ds_read_b128 v[28:31], v8 offset:50176
    s_waitcnt vmcnt(14) lgkmcnt(2)
    v_mfma_f32_32x32x16_bf16 v[64:79], a[64:67], v[16:19], v[64:79]
    v_mfma_f32_32x32x16_bf16 v[80:95], a[68:71], v[16:19], v[80:95]
    v_mfma_f32_32x32x16_bf16 v[96:111], a[64:67], v[20:23], v[96:111]
    v_mfma_f32_32x32x16_bf16 v[112:127], a[68:71], v[20:23], v[112:127]
    ds_read_b128 v[16:19], v8 offset:22528
    ds_read_b128 v[20:23], v8 offset:51200
    s_waitcnt vmcnt(12) lgkmcnt(2)
    v_mfma_f32_32x32x16_bf16 v[64:79], a[72:75], v[24:27], v[64:79]
    v_mfma_f32_32x32x16_bf16 v[80:95], a[76:79], v[24:27], v[80:95]
    v_mfma_f32_32x32x16_bf16 v[96:111], a[72:75], v[28:31], v[96:111]
    v_mfma_f32_32x32x16_bf16 v[112:127], a[76:79], v[28:31], v[112:127]
    ds_read_b128 v[24:27], v8 offset:23552
    ds_read_b128 v[28:31], v8 offset:52224
    s_waitcnt vmcnt(10) lgkmcnt(2)
    v_mfma_f32_32x32x16_bf16 v[64:79], a[80:83], v[16:19], v[64:79]
    v_mfma_f32_32x32x16_bf16 v[80:95], a[84:87], v[16:19], v[80:95]
    v_mfma_f32_32x32x16_bf16 v[96:111], a[80:83], v[20:23], v[96:111]
    v_mfma_f32_32x32x16_bf16 v[112:127], a[84:87], v[20:23], v[112:127]
    ds_read_b128 v[16:19], v8 offset:24576
    ds_read_b128 v[20:23], v8 offset:53248
    s_waitcnt vmcnt(8) lgkmcnt(2)
    v_mfma_f32_32x32x16_bf16 v[64:79], a[88:91], v[24:27], v[64:79]
    v_mfma_f32_32x32x16_bf16 v[80:95], a[92:95], v[24:27], v[80:95]
    v_mfma_f32_32x32x16_bf16 v[96:111], a[88:91], v[28:31], v[96:111]
    v_mfma_f32_32x32x16_bf16 v[112:127], a[92:95], v[28:31], v[112:127]
    ds_read_b128 v[24:27], v8 offset:25600
    ds_read_b128 v[28:31], v8 offset:54272
    s_waitcnt vmcnt(6) lgkmcnt(2)
    v_mfma_f32_32x32x16_bf16 v[64:79], a[0:3], v[16:19], v[64:79]
    v_mfma_f32_32x32x16_bf16 v[80:95], a[4:7], v[16:19], v[80:95]
    v_mfma_f32_32x32x16_bf16 v[96:111], a[0:3], v[20:23], v[96:111]
    v_mfma_f32_32x32x16_bf16 v[112:127], a[4:7], v[20:23], v[112:127]
    ds_read_b128 v[16:19], v8 offset:26624
    ds_read_b128 v[20:23], v8 offset:55296
    s_waitcnt vmcnt(4) lgkmcnt(2)
    v_mfma_f32_32x32x16_bf16 v[64:79], a[8:11], v[24:27], v[64:79]
    v_mfma_f32_32x32x16_bf16 v[80:95], a[12:15], v[24:27], v[80:95]
    v_mfma_f32_32x32x16_bf16 v[96:111], a[8:11], v[28:31], v[96:111]
    v_mfma_f32_32x32x16_bf16 v[112:127], a[12:15], v[28:31], v[112:127]
    ds_read_b128 v[24:27], v8 offset:27648
    ds_read_b128 v[28:31], v8 offset:56320
    s_waitcnt vmcnt(2) lgkmcnt(2)
    v_mfma_f32_32x32x16_bf16 v[64:79], a[16:19], v[16:19], v[64:79]
    v_mfma_f32_32x32x16_bf16 v[80:95], a[20:23], v[16:19], v[80:95]
    v_mfma_f32_32x32x16_bf16 v[96:111], a[16:19], v[20:23], v[96:111]
    v_mfma_f32_32x32x16_bf16 v[112:127], a[20:23], v[20:23], v[112:127]
    s_waitcnt vmcnt(0) lgkmcnt(0)
    v_mfma_f32_32x32x16_bf16 v[64:79], a[24:27], v[24:27], v[64:79]
    v_mfma_f32_32x32x16_bf16 v[80:95], a[28:31], v[24:27], v[80:95]
    v_mfma_f32_32x32x16_bf16 v[96:111], a[24:27], v[28:31], v[96:111]
    v_mfma_f32_32x32x16_bf16 v[112:127], a[28:31], v[28:31], v[112:127]
    v_mul_f32 v4, 0x3b124925, v4
    v_mul_f32 v5, 0x3b124925, v5
    v_fma_f32 v5, -v4, v4, v5
    v_max_f32 v5, 0, v5
    v_cvt_pk_bf16_f32 v12, v5, v4
    v_lshlrev_b32 v13, 16, v12
    v_and_b32 v12, 0xffff0000, v12
    v_add_f32 v13, 0x3727c5ac, v13
    v_cvt_pk_bf16_f32 v13, v13, v13
    v_lshlrev_b32 v13, 16, v13
    v_sqrt_f32 v13, v13
    s_nop 0
    v_cvt_pk_bf16_f32 v13, v13, v13
    v_lshlrev_b32 v13, 16, v13
    v_rcp_f32 v4, v13
    s_nop 0
    v_mul_f32 v5, v12, v4
    v_sub_f32 v5, 0, v5
    v_mul_f32 v6, 0x3b124925, v6
    v_mul_f32 v7, 0x3b124925, v7
    v_fma_f32 v7, -v6, v6, v7
    v_max_f32 v7, 0, v7
    v_cvt_pk_bf16_f32 v12, v7, v6
    v_lshlrev_b32 v13, 16, v12
    v_and_b32 v12, 0xffff0000, v12
    v_add_f32 v13, 0x3727c5ac, v13
    v_cvt_pk_bf16_f32 v13, v13, v13
    v_lshlrev_b32 v13, 16, v13
    v_sqrt_f32 v13, v13
    s_nop 0
    v_cvt_pk_bf16_f32 v13, v13, v13
    v_lshlrev_b32 v13, 16, v13
    v_rcp_f32 v6, v13
    s_nop 0
    v_mul_f32 v7, v12, v6
    v_sub_f32 v7, 0, v7
    v_mov_b32 v12, 0xbfb8aa3b
    v_mov_b32 v13, 1.0
    v_pk_mul_f32 v[14:15], v[32:33], v[4:5] op_sel:[0,1] op_sel_hi:[1,1]
    v_pk_fma_f32 v[64:65], v[64:65], v[4:5], v[14:15] op_sel_hi:[1,0,1]
    v_pk_mul_f32 v[14:15], v[34:35], v[4:5] op_sel:[0,1] op_sel_hi:[1,1]
    v_pk_fma_f32 v[66:67], v[66:67], v[4:5], v[14:15] op_sel_hi:[1,0,1]
    v_pk_mul_f32 v[14:15], v[36:37], v[4:5] op_sel:[0,1] op_sel_hi:[1,1]
    v_pk_fma_f32 v[68:69], v[68:69], v[4:5], v[14:15] op_sel_hi:[1,0,1]
    v_pk_mul_f32 v[14:15], v[38:39], v[4:5] op_sel:[0,1] op_sel_hi:[1,1]
    v_pk_fma_f32 v[70:71], v[70:71], v[4:5], v[14:15] op_sel_hi:[1,0,1]
    v_pk_mul_f32 v[14:15], v[40:41], v[4:5] op_sel:[0,1] op_sel_hi:[1,1]
    v_pk_fma_f32 v[72:73], v[72:73], v[4:5], v[14:15] op_sel_hi:[1,0,1]
    v_pk_mul_f32 v[14:15], v[42:43], v[4:5] op_sel:[0,1] op_sel_hi:[1,1]
    v_pk_fma_f32 v[74:75], v[74:75], v[4:5], v[14:15] op_sel_hi:[1,0,1]
    v_pk_mul_f32 v[14:15], v[44:45], v[4:5] op_sel:[0,1] op_sel_hi:[1,1]
    v_pk_fma_f32 v[76:77], v[76:77], v[4:5], v[14:15] op_sel_hi:[1,0,1]
    v_pk_mul_f32 v[14:15], v[46:47], v[4:5] op_sel:[0,1] op_sel_hi:[1,1]
    v_pk_fma_f32 v[78:79], v[78:79], v[4:5], v[14:15] op_sel_hi:[1,0,1]
    v_pk_mul_f32 v[64:65], v[64:65], v[12:13] op_sel_hi:[1,0]
    v_pk_mul_f32 v[66:67], v[66:67], v[12:13] op_sel_hi:[1,0]
    v_pk_mul_f32 v[68:69], v[68:69], v[12:13] op_sel_hi:[1,0]
    v_pk_mul_f32 v[70:71], v[70:71], v[12:13] op_sel_hi:[1,0]
    v_pk_mul_f32 v[72:73], v[72:73], v[12:13] op_sel_hi:[1,0]
    v_pk_mul_f32 v[74:75], v[74:75], v[12:13] op_sel_hi:[1,0]
    v_pk_mul_f32 v[76:77], v[76:77], v[12:13] op_sel_hi:[1,0]
    v_pk_mul_f32 v[78:79], v[78:79], v[12:13] op_sel_hi:[1,0]
    v_exp_f32 v64, v64
    v_exp_f32 v65, v65
    v_exp_f32 v66, v66
    v_exp_f32 v67, v67
    v_exp_f32 v68, v68
    v_exp_f32 v69, v69
    v_exp_f32 v70, v70
    v_exp_f32 v71, v71
    v_exp_f32 v72, v72
    v_exp_f32 v73, v73
    v_exp_f32 v74, v74
    v_exp_f32 v75, v75
    v_exp_f32 v76, v76
    v_exp_f32 v77, v77
    v_exp_f32 v78, v78
    v_exp_f32 v79, v79
    v_pk_mul_f32 v[14:15], v[48:49], v[4:5] op_sel:[0,1] op_sel_hi:[1,1]
    v_pk_fma_f32 v[80:81], v[80:81], v[4:5], v[14:15] op_sel_hi:[1,0,1]
    v_pk_mul_f32 v[14:15], v[50:51], v[4:5] op_sel:[0,1] op_sel_hi:[1,1]
    v_pk_fma_f32 v[82:83], v[82:83], v[4:5], v[14:15] op_sel_hi:[1,0,1]
    v_pk_mul_f32 v[14:15], v[52:53], v[4:5] op_sel:[0,1] op_sel_hi:[1,1]
    v_pk_fma_f32 v[84:85], v[84:85], v[4:5], v[14:15] op_sel_hi:[1,0,1]
    v_pk_mul_f32 v[14:15], v[54:55], v[4:5] op_sel:[0,1] op_sel_hi:[1,1]
    v_pk_fma_f32 v[86:87], v[86:87], v[4:5], v[14:15] op_sel_hi:[1,0,1]
    v_pk_mul_f32 v[14:15], v[56:57], v[4:5] op_sel:[0,1] op_sel_hi:[1,1]
    v_pk_fma_f32 v[88:89], v[88:89], v[4:5], v[14:15] op_sel_hi:[1,0,1]
    v_pk_mul_f32 v[14:15], v[58:59], v[4:5] op_sel:[0,1] op_sel_hi:[1,1]
    v_pk_fma_f32 v[90:91], v[90:91], v[4:5], v[14:15] op_sel_hi:[1,0,1]
    v_pk_mul_f32 v[14:15], v[60:61], v[4:5] op_sel:[0,1] op_sel_hi:[1,1]
    v_pk_fma_f32 v[92:93], v[92:93], v[4:5], v[14:15] op_sel_hi:[1,0,1]
    v_pk_mul_f32 v[14:15], v[62:63], v[4:5] op_sel:[0,1] op_sel_hi:[1,1]
    v_pk_fma_f32 v[94:95], v[94:95], v[4:5], v[14:15] op_sel_hi:[1,0,1]
    v_pk_add_f32 v[64:65], v[64:65], v[12:13] op_sel:[0,1] op_sel_hi:[1,1]
    v_pk_add_f32 v[66:67], v[66:67], v[12:13] op_sel:[0,1] op_sel_hi:[1,1]
    v_pk_add_f32 v[68:69], v[68:69], v[12:13] op_sel:[0,1] op_sel_hi:[1,1]
    v_pk_add_f32 v[70:71], v[70:71], v[12:13] op_sel:[0,1] op_sel_hi:[1,1]
    v_pk_add_f32 v[72:73], v[72:73], v[12:13] op_sel:[0,1] op_sel_hi:[1,1]
    v_pk_add_f32 v[74:75], v[74:75], v[12:13] op_sel:[0,1] op_sel_hi:[1,1]
    v_pk_add_f32 v[76:77], v[76:77], v[12:13] op_sel:[0,1] op_sel_hi:[1,1]
    v_pk_add_f32 v[78:79], v[78:79], v[12:13] op_sel:[0,1] op_sel_hi:[1,1]
    v_rcp_f32 v64, v64
    v_rcp_f32 v65, v65
    v_rcp_f32 v66, v66
    v_rcp_f32 v67, v67
    v_rcp_f32 v68, v68
    v_rcp_f32 v69, v69
    v_rcp_f32 v70, v70
    v_rcp_f32 v71, v71
    v_rcp_f32 v72, v72
    v_rcp_f32 v73, v73
    v_rcp_f32 v74, v74
    v_rcp_f32 v75, v75
    v_rcp_f32 v76, v76
    v_rcp_f32 v77, v77
    v_rcp_f32 v78, v78
    v_rcp_f32 v79, v79
    s_nop 0
    v_pk_mul_f32 v[64:65], v[64:65], v[80:81]
    v_pk_mul_f32 v[66:67], v[66:67], v[82:83]
    v_pk_mul_f32 v[68:69], v[68:69], v[84:85]
    v_pk_mul_f32 v[70:71], v[70:71], v[86:87]
    v_pk_mul_f32 v[72:73], v[72:73], v[88:89]
    v_pk_mul_f32 v[74:75], v[74:75], v[90:91]
    v_pk_mul_f32 v[76:77], v[76:77], v[92:93]
    v_pk_mul_f32 v[78:79], v[78:79], v[94:95]
    v_cvt_pk_bf16_f32 v128, v64, v65
    v_cvt_pk_bf16_f32 v129, v66, v67
    v_cvt_pk_bf16_f32 v130, v68, v69
    v_cvt_pk_bf16_f32 v131, v70, v71
    v_cvt_pk_bf16_f32 v132, v72, v73
    v_cvt_pk_bf16_f32 v133, v74, v75
    v_cvt_pk_bf16_f32 v134, v76, v77
    v_cvt_pk_bf16_f32 v135, v78, v79
    s_lshl_b32 s57, s73, 2
    s_lshl_b32 s58, s76, 1
    s_add_u32 s57, s57, s58
    s_add_u32 s57, s57, 0
    s_mul_i32 s57, s57, 56
    s_add_u32 s57, s57, s55
    s_lshl_b32 s57, s57, 11
    s_add_u32 s57, s57, s84
    buffer_store_dwordx4 v[128:131], v1, s[28:31], s57 offen offset:0 sc1
    buffer_store_dwordx4 v[132:135], v1, s[28:31], s57 offen offset:1024 sc1
    v_pk_mul_f32 v[14:15], v[32:33], v[6:7] op_sel:[0,1] op_sel_hi:[1,1]
    v_pk_fma_f32 v[96:97], v[96:97], v[6:7], v[14:15] op_sel_hi:[1,0,1]
    v_pk_mul_f32 v[14:15], v[34:35], v[6:7] op_sel:[0,1] op_sel_hi:[1,1]
    v_pk_fma_f32 v[98:99], v[98:99], v[6:7], v[14:15] op_sel_hi:[1,0,1]
    v_pk_mul_f32 v[14:15], v[36:37], v[6:7] op_sel:[0,1] op_sel_hi:[1,1]
    v_pk_fma_f32 v[100:101], v[100:101], v[6:7], v[14:15] op_sel_hi:[1,0,1]
    v_pk_mul_f32 v[14:15], v[38:39], v[6:7] op_sel:[0,1] op_sel_hi:[1,1]
    v_pk_fma_f32 v[102:103], v[102:103], v[6:7], v[14:15] op_sel_hi:[1,0,1]
    v_pk_mul_f32 v[14:15], v[40:41], v[6:7] op_sel:[0,1] op_sel_hi:[1,1]
    v_pk_fma_f32 v[104:105], v[104:105], v[6:7], v[14:15] op_sel_hi:[1,0,1]
    v_pk_mul_f32 v[14:15], v[42:43], v[6:7] op_sel:[0,1] op_sel_hi:[1,1]
    v_pk_fma_f32 v[106:107], v[106:107], v[6:7], v[14:15] op_sel_hi:[1,0,1]
    v_pk_mul_f32 v[14:15], v[44:45], v[6:7] op_sel:[0,1] op_sel_hi:[1,1]
    v_pk_fma_f32 v[108:109], v[108:109], v[6:7], v[14:15] op_sel_hi:[1,0,1]
    v_pk_mul_f32 v[14:15], v[46:47], v[6:7] op_sel:[0,1] op_sel_hi:[1,1]
    v_pk_fma_f32 v[110:111], v[110:111], v[6:7], v[14:15] op_sel_hi:[1,0,1]
    v_pk_mul_f32 v[96:97], v[96:97], v[12:13] op_sel_hi:[1,0]
    v_pk_mul_f32 v[98:99], v[98:99], v[12:13] op_sel_hi:[1,0]
    v_pk_mul_f32 v[100:101], v[100:101], v[12:13] op_sel_hi:[1,0]
    v_pk_mul_f32 v[102:103], v[102:103], v[12:13] op_sel_hi:[1,0]
    v_pk_mul_f32 v[104:105], v[104:105], v[12:13] op_sel_hi:[1,0]
    v_pk_mul_f32 v[106:107], v[106:107], v[12:13] op_sel_hi:[1,0]
    v_pk_mul_f32 v[108:109], v[108:109], v[12:13] op_sel_hi:[1,0]
    v_pk_mul_f32 v[110:111], v[110:111], v[12:13] op_sel_hi:[1,0]
    v_exp_f32 v96, v96
    v_exp_f32 v97, v97
    v_exp_f32 v98, v98
    v_exp_f32 v99, v99
    v_exp_f32 v100, v100
    v_exp_f32 v101, v101
    v_exp_f32 v102, v102
    v_exp_f32 v103, v103
    v_exp_f32 v104, v104
    v_exp_f32 v105, v105
    v_exp_f32 v106, v106
    v_exp_f32 v107, v107
    v_exp_f32 v108, v108
    v_exp_f32 v109, v109
    v_exp_f32 v110, v110
    v_exp_f32 v111, v111
    v_pk_mul_f32 v[14:15], v[48:49], v[6:7] op_sel:[0,1] op_sel_hi:[1,1]
    v_pk_fma_f32 v[112:113], v[112:113], v[6:7], v[14:15] op_sel_hi:[1,0,1]
    v_pk_mul_f32 v[14:15], v[50:51], v[6:7] op_sel:[0,1] op_sel_hi:[1,1]
    v_pk_fma_f32 v[114:115], v[114:115], v[6:7], v[14:15] op_sel_hi:[1,0,1]
    v_pk_mul_f32 v[14:15], v[52:53], v[6:7] op_sel:[0,1] op_sel_hi:[1,1]
    v_pk_fma_f32 v[116:117], v[116:117], v[6:7], v[14:15] op_sel_hi:[1,0,1]
    v_pk_mul_f32 v[14:15], v[54:55], v[6:7] op_sel:[0,1] op_sel_hi:[1,1]
    v_pk_fma_f32 v[118:119], v[118:119], v[6:7], v[14:15] op_sel_hi:[1,0,1]
    v_pk_mul_f32 v[14:15], v[56:57], v[6:7] op_sel:[0,1] op_sel_hi:[1,1]
    v_pk_fma_f32 v[120:121], v[120:121], v[6:7], v[14:15] op_sel_hi:[1,0,1]
    v_pk_mul_f32 v[14:15], v[58:59], v[6:7] op_sel:[0,1] op_sel_hi:[1,1]
    v_pk_fma_f32 v[122:123], v[122:123], v[6:7], v[14:15] op_sel_hi:[1,0,1]
    v_pk_mul_f32 v[14:15], v[60:61], v[6:7] op_sel:[0,1] op_sel_hi:[1,1]
    v_pk_fma_f32 v[124:125], v[124:125], v[6:7], v[14:15] op_sel_hi:[1,0,1]
    v_pk_mul_f32 v[14:15], v[62:63], v[6:7] op_sel:[0,1] op_sel_hi:[1,1]
    v_pk_fma_f32 v[126:127], v[126:127], v[6:7], v[14:15] op_sel_hi:[1,0,1]
    v_pk_add_f32 v[96:97], v[96:97], v[12:13] op_sel:[0,1] op_sel_hi:[1,1]
    v_pk_add_f32 v[98:99], v[98:99], v[12:13] op_sel:[0,1] op_sel_hi:[1,1]
    v_pk_add_f32 v[100:101], v[100:101], v[12:13] op_sel:[0,1] op_sel_hi:[1,1]
    v_pk_add_f32 v[102:103], v[102:103], v[12:13] op_sel:[0,1] op_sel_hi:[1,1]
    v_pk_add_f32 v[104:105], v[104:105], v[12:13] op_sel:[0,1] op_sel_hi:[1,1]
    v_pk_add_f32 v[106:107], v[106:107], v[12:13] op_sel:[0,1] op_sel_hi:[1,1]
    v_pk_add_f32 v[108:109], v[108:109], v[12:13] op_sel:[0,1] op_sel_hi:[1,1]
    v_pk_add_f32 v[110:111], v[110:111], v[12:13] op_sel:[0,1] op_sel_hi:[1,1]
    v_rcp_f32 v96, v96
    v_rcp_f32 v97, v97
    v_rcp_f32 v98, v98
    v_rcp_f32 v99, v99
    v_rcp_f32 v100, v100
    v_rcp_f32 v101, v101
    v_rcp_f32 v102, v102
    v_rcp_f32 v103, v103
    v_rcp_f32 v104, v104
    v_rcp_f32 v105, v105
    v_rcp_f32 v106, v106
    v_rcp_f32 v107, v107
    v_rcp_f32 v108, v108
    v_rcp_f32 v109, v109
    v_rcp_f32 v110, v110
    v_rcp_f32 v111, v111
    s_nop 0
    v_pk_mul_f32 v[96:97], v[96:97], v[112:113]
    v_pk_mul_f32 v[98:99], v[98:99], v[114:115]
    v_pk_mul_f32 v[100:101], v[100:101], v[116:117]
    v_pk_mul_f32 v[102:103], v[102:103], v[118:119]
    v_pk_mul_f32 v[104:105], v[104:105], v[120:121]
    v_pk_mul_f32 v[106:107], v[106:107], v[122:123]
    v_pk_mul_f32 v[108:109], v[108:109], v[124:125]
    v_pk_mul_f32 v[110:111], v[110:111], v[126:127]
    v_cvt_pk_bf16_f32 v136, v96, v97
    v_cvt_pk_bf16_f32 v137, v98, v99
    v_cvt_pk_bf16_f32 v138, v100, v101
    v_cvt_pk_bf16_f32 v139, v102, v103
    v_cvt_pk_bf16_f32 v140, v104, v105
    v_cvt_pk_bf16_f32 v141, v106, v107
    v_cvt_pk_bf16_f32 v142, v108, v109
    v_cvt_pk_bf16_f32 v143, v110, v111
    s_lshl_b32 s57, s73, 2
    s_lshl_b32 s58, s76, 1
    s_add_u32 s57, s57, s58
    s_add_u32 s57, s57, 1
    s_mul_i32 s57, s57, 56
    s_add_u32 s57, s57, s55
    s_lshl_b32 s57, s57, 11
    s_add_u32 s57, s57, s84
    buffer_store_dwordx4 v[136:139], v1, s[28:31], s57 offen offset:0 sc1
    buffer_store_dwordx4 v[140:143], v1, s[28:31], s57 offen offset:1024 sc1
    s_waitcnt vmcnt(0) lgkmcnt(0)
    s_barrier
    s_cmp_lg_u32 s52, 0
    s_cbranch_scc1 SIG7
    s_lshl_b32 s57, s73, 7
    s_add_u32 s57, s57, s91
    v_mov_b32 v3, 1
    v_mov_b32 v9, 0
    s_mov_b64 exec, 1
    buffer_atomic_add v3, v9, s[28:31], s57 offen sc1
    s_mov_b64 exec, -1
SIG7:
    s_mul_i32 s53, s52, 7
    s_lshl_b32 s57, s71, 1
    s_add_u32 s57, s57, 0
    s_mul_i32 s57, s57, 56
    s_add_u32 s57, s57, s53
    s_lshl_b32 s57, s57, 11
    s_add_u32 s66, s57, s84
    s_lshl_b32 s57, s70, 1
    s_add_u32 s57, s57, 0
    s_mul_i32 s57, s57, 56
    s_add_u32 s57, s57, s53
    s_lshl_b32 s57, s57, 11
    s_add_u32 s68, s57, 5079040
    s_lshl_b32 s57, s71, 1
    s_add_u32 s57, s57, 1
    s_mul_i32 s57, s57, 56
    s_add_u32 s57, s57, s53
    s_lshl_b32 s57, s57, 11
    s_add_u32 s67, s57, s84
    s_lshl_b32 s57, s70, 1
    s_add_u32 s57, s57, 1
    s_mul_i32 s57, s57, 56
    s_add_u32 s57, s57, s53
    s_lshl_b32 s57, s57, 11
    s_add_u32 s69, s57, 5079040
    s_add_u32 s57, s68, 0
    buffer_load_dwordx4 v[24:27], v1, s[28:31], s57 offen offset:0
    s_add_u32 s57, s69, 0
    buffer_load_dwordx4 v[28:31], v1, s[28:31], s57 offen offset:0
    s_add_u32 s57, s68, 0
    buffer_load_dwordx4 v[40:43], v1, s[28:31], s57 offen offset:1024
    s_add_u32 s57, s69, 0
    buffer_load_dwordx4 v[44:47], v1, s[28:31], s57 offen offset:1024
    s_add_u32 s57, s68, 0
    buffer_load_dwordx4 v[56:59], v1, s[28:31], s57 offen offset:2048
    s_add_u32 s57, s69, 0
    buffer_load_dwordx4 v[60:63], v1, s[28:31], s57 offen offset:2048
    s_add_u32 s57, s68, 0
    buffer_load_dwordx4 v[72:75], v1, s[28:31], s57 offen offset:3072
    s_add_u32 s57, s69, 0
    buffer_load_dwordx4 v[76:79], v1, s[28:31], s57 offen offset:3072
    s_add_u32 s57, s68, 4096
    buffer_load_dwordx4 v[88:91], v1, s[28:31], s57 offen offset:0
    s_add_u32 s57, s69, 4096
    buffer_load_dwordx4 v[92:95], v1, s[28:31], s57 offen offset:0
    s_add_u32 s57, s68, 4096
    buffer_load_dwordx4 v[104:107], v1, s[28:31], s57 offen offset:1024
    s_add_u32 s57, s69, 4096
    buffer_load_dwordx4 v[108:111], v1, s[28:31], s57 offen offset:1024
    s_add_u32 s57, s68, 4096
    buffer_load_dwordx4 v[120:123], v1, s[28:31], s57 offen offset:2048
    s_add_u32 s57, s69, 4096
    buffer_load_dwordx4 v[124:127], v1, s[28:31], s57 offen offset:2048
    s_add_u32 s57, s68, 4096
    buffer_load_dwordx4 v[136:139], v1, s[28:31], s57 offen offset:3072
    s_add_u32 s57, s69, 4096
    buffer_load_dwordx4 v[140:143], v1, s[28:31], s57 offen offset:3072
    s_add_u32 s57, s68, 8192
    buffer_load_dwordx4 v[152:155], v1, s[28:31], s57 offen offset:0
    s_add_u32 s57, s69, 8192
    buffer_load_dwordx4 v[156:159], v1, s[28:31], s57 offen offset:0
    s_bfe_u32 s62, s52, 0x10001
    s_lshl_b32 s59, s71, 1
    s_add_u32 s62, s62, s59
    s_mul_i32 s63, s62, 28
    s_lshl_b32 s59, s70, 2
    s_add_u32 s63, s63, s59
    s_and_b32 s59, s52, 1
    s_lshl_b32 s59, s59, 1
    s_add_u32 s63, s63, s59
    s_lshl_b32 s63, s63, 10
    v_lshlrev_b32 v13, 4, v10
    v_lshl_add_u32 v13, v11, 10, v13
    s_lshr_b32 s54, s71, 1
    s_cmp_lg_u32 s52, 0
    s_cbranch_scc1 WT8_P
    s_lshl_b32 s57, s54, 7
    s_add_u32 s57, s57, s91
    v_lshlrev_b32 v9, 7, v2
    s_mov_b64 exec, 1
    s_mov_b32 s58, 0
WT8_L:
    buffer_load_dword v3, v9, s[28:31], s57 offen sc1
    s_waitcnt vmcnt(0)
    v_cmp_gt_u32 vcc, 14, v3
    s_add_u32 s58, s58, 1
    s_cmp_eq_u64 vcc, 0
    s_cbranch_scc1 WT8_E
    s_sleep 1
    s_cmp_lt_u32 s58, 0x40000
    s_cbranch_scc1 WT8_L
WT8_E:
    s_mov_b64 exec, -1
    s_barrier
    s_branch WT8_D
WT8_P:
    s_barrier
WT8_D:
    s_add_u32 s57, s66, 0
    buffer_load_dwordx4 v[16:19], v1, s[28:31], s57 offen offset:0
    s_add_u32 s57, s67, 0
    buffer_load_dwordx4 v[20:23], v1, s[28:31], s57 offen offset:0
    s_add_u32 s57, s66, 0
    buffer_load_dwordx4 v[32:35], v1, s[28:31], s57 offen offset:1024
    s_add_u32 s57, s67, 0
    buffer_load_dwordx4 v[36:39], v1, s[28:31], s57 offen offset:1024
    s_add_u32 s57, s66, 0
    buffer_load_dwordx4 v[48:51], v1, s[28:31], s57 offen offset:2048
    s_add_u32 s57, s67, 0
    buffer_load_dwordx4 v[52:55], v1, s[28:31], s57 offen offset:2048
    s_add_u32 s57, s66, 0
    buffer_load_dwordx4 v[64:67], v1, s[28:31], s57 offen offset:3072
    s_add_u32 s57, s67, 0
    buffer_load_dwordx4 v[68:71], v1, s[28:31], s57 offen offset:3072
    s_add_u32 s57, s66, 4096
    buffer_load_dwordx4 v[80:83], v1, s[28:31], s57 offen offset:0
    s_add_u32 s57, s67, 4096
    buffer_load_dwordx4 v[84:87], v1, s[28:31], s57 offen offset:0
    s_add_u32 s57, s66, 4096
    buffer_load_dwordx4 v[96:99], v1, s[28:31], s57 offen offset:1024
    s_add_u32 s57, s67, 4096
    buffer_load_dwordx4 v[100:103], v1, s[28:31], s57 offen offset:1024
    s_add_u32 s57, s66, 4096
    buffer_load_dwordx4 v[112:115], v1, s[28:31], s57 offen offset:2048
    s_add_u32 s57, s67, 4096
    buffer_load_dwordx4 v[116:119], v1, s[28:31], s57 offen offset:2048
    s_add_u32 s57, s66, 4096
    buffer_load_dwordx4 v[128:131], v1, s[28:31], s57 offen offset:3072
    s_add_u32 s57, s67, 4096
    buffer_load_dwordx4 v[132:135], v1, s[28:31], s57 offen offset:3072
    s_add_u32 s57, s66, 8192
    buffer_load_dwordx4 v[144:147], v1, s[28:31], s57 offen offset:0
    s_add_u32 s57, s67, 8192
    buffer_load_dwordx4 v[148:151], v1, s[28:31], s57 offen offset:0
    s_waitcnt vmcnt(16)
    v_mfma_f32_32x32x16_bf16 a[0:15], v[24:27], v[16:19], 0
    v_mfma_f32_32x32x16_bf16 a[16:31], v[28:31], v[16:19], 0
    v_mfma_f32_32x32x16_bf16 a[32:47], v[24:27], v[20:23], 0
    v_mfma_f32_32x32x16_bf16 a[48:63], v[28:31], v[20:23], 0
    s_add_u32 s57, s66, 8192
    buffer_load_dwordx4 v[16:19], v1, s[28:31], s57 offen offset:1024
    s_add_u32 s57, s67, 8192
    buffer_load_dwordx4 v[20:23], v1, s[28:31], s57 offen offset:1024
    s_add_u32 s57, s68, 8192
    buffer_load_dwordx4 v[24:27], v1, s[28:31], s57 offen offset:1024
    s_add_u32 s57, s69, 8192
    buffer_load_dwordx4 v[28:31], v1, s[28:31], s57 offen offset:1024
    s_waitcnt vmcnt(18)
    v_mfma_f32_32x32x16_bf16 a[0:15], v[40:43], v[32:35], a[0:15]
    v_mfma_f32_32x32x16_bf16 a[16:31], v[44:47], v[32:35], a[16:31]
    v_mfma_f32_32x32x16_bf16 a[32:47], v[40:43], v[36:39], a[32:47]
    v_mfma_f32_32x32x16_bf16 a[48:63], v[44:47], v[36:39], a[48:63]
    s_add_u32 s57, s66, 8192
    buffer_load_dwordx4 v[32:35], v1, s[28:31], s57 offen offset:2048
    s_add_u32 s57, s67, 8192
    buffer_load_dwordx4 v[36:39], v1, s[28:31], s57 offen offset:2048
    s_add_u32 s57, s68, 8192
    buffer_load_dwordx4 v[40:43], v1, s[28:31], s57 offen offset:2048
    s_add_u32 s57, s69, 8192
    buffer_load_dwordx4 v[44:47], v1, s[28:31], s57 offen offset:2048
    s_waitcnt vmcnt(20)
    v_mfma_f32_32x32x16_bf16 a[0:15], v[56:59], v[48:51], a[0:15]
    v_mfma_f32_32x32x16_bf16 a[16:31], v[60:63], v[48:51], a[16:31]
    v_mfma_f32_32x32x16_bf16 a[32:47], v[56:59], v[52:55], a[32:47]
    v_mfma_f32_32x32x16_bf16 a[48:63], v[60:63], v[52:55], a[48:63]
    s_add_u32 s57, s66, 8192
    buffer_load_dwordx4 v[48:51], v1, s[28:31], s57 offen offset:3072
    s_add_u32 s57, s67, 8192
    buffer_load_dwordx4 v[52:55], v1, s[28:31], s57 offen offset:3072
    s_add_u32 s57, s68, 8192
    buffer_load_dwordx4 v[56:59], v1, s[28:31], s57 offen offset:3072
    s_add_u32 s57, s69, 8192
    buffer_load_dwordx4 v[60:63], v1, s[28:31], s57 offen offset:3072
    s_waitcnt vmcnt(22)
    v_mfma_f32_32x32x16_bf16 a[0:15], v[72:75], v[64:67], a[0:15]
    v_mfma_f32_32x32x16_bf16 a[16:31], v[76:79], v[64:67], a[16:31]
    v_mfma_f32_32x32x16_bf16 a[32:47], v[72:75], v[68:71], a[32:47]
    v_mfma_f32_32x32x16_bf16 a[48:63], v[76:79], v[68:71], a[48:63]
    s_add_u32 s57, s66, 12288
    buffer_load_dwordx4 v[64:67], v1, s[28:31], s57 offen offset:0
    s_add_u32 s57, s67, 12288
    buffer_load_dwordx4 v[68:71], v1, s[28:31], s57 offen offset:0
    s_add_u32 s57, s68, 12288
    buffer_load_dwordx4 v[72:75], v1, s[28:31], s57 offen offset:0
    s_add_u32 s57, s69, 12288
    buffer_load_dwordx4 v[76:79], v1, s[28:31], s57 offen offset:0
    s_waitcnt vmcnt(24)
    v_mfma_f32_32x32x16_bf16 a[0:15], v[88:91], v[80:83], a[0:15]
    v_mfma_f32_32x32x16_bf16 a[16:31], v[92:95], v[80:83], a[16:31]
    v_mfma_f32_32x32x16_bf16 a[32:47], v[88:91], v[84:87], a[32:47]
    v_mfma_f32_32x32x16_bf16 a[48:63], v[92:95], v[84:87], a[48:63]
    s_add_u32 s57, s66, 12288
    buffer_load_dwordx4 v[80:83], v1, s[28:31], s57 offen offset:1024
    s_add_u32 s57, s67, 12288
    buffer_load_dwordx4 v[84:87], v1, s[28:31], s57 offen offset:1024
    s_add_u32 s57, s68, 12288
    buffer_load_dwordx4 v[88:91], v1, s[28:31], s57 offen offset:1024
    s_add_u32 s57, s69, 12288
    buffer_load_dwordx4 v[92:95], v1, s[28:31], s57 offen offset:1024
    s_waitcnt vmcnt(26)
    v_mfma_f32_32x32x16_bf16 a[0:15], v[104:107], v[96:99], a[0:15]
    v_mfma_f32_32x32x16_bf16 a[16:31], v[108:111], v[96:99], a[16:31]
    v_mfma_f32_32x32x16_bf16 a[32:47], v[104:107], v[100:103], a[32:47]
    v_mfma_f32_32x32x16_bf16 a[48:63], v[108:111], v[100:103], a[48:63]
    s_waitcnt vmcnt(24)
    v_mfma_f32_32x32x16_bf16 a[0:15], v[120:123], v[112:115], a[0:15]
    v_mfma_f32_32x32x16_bf16 a[16:31], v[124:127], v[112:115], a[16:31]
    v_mfma_f32_32x32x16_bf16 a[32:47], v[120:123], v[116:119], a[32:47]
    v_mfma_f32_32x32x16_bf16 a[48:63], v[124:127], v[116:119], a[48:63]
    s_waitcnt vmcnt(22)
    v_mfma_f32_32x32x16_bf16 a[0:15], v[136:139], v[128:131], a[0:15]
    v_mfma_f32_32x32x16_bf16 a[16:31], v[140:143], v[128:131], a[16:31]
    v_mfma_f32_32x32x16_bf16 a[32:47], v[136:139], v[132:135], a[32:47]
    v_mfma_f32_32x32x16_bf16 a[48:63], v[140:143], v[132:135], a[48:63]
    s_waitcnt vmcnt(20)
    v_mfma_f32_32x32x16_bf16 a[0:15], v[152:155], v[144:147], a[0:15]
    v_mfma_f32_32x32x16_bf16 a[16:31], v[156:159], v[144:147], a[16:31]
    v_mfma_f32_32x32x16_bf16 a[32:47], v[152:155], v[148:151], a[32:47]
    v_mfma_f32_32x32x16_bf16 a[48:63], v[156:159], v[148:151], a[48:63]
    s_waitcnt vmcnt(16)
    v_mfma_f32_32x32x16_bf16 a[0:15], v[24:27], v[16:19], a[0:15]
    v_mfma_f32_32x32x16_bf16 a[16:31], v[28:31], v[16:19], a[16:31]
    v_mfma_f32_32x32x16_bf16 a[32:47], v[24:27], v[20:23], a[32:47]
    v_mfma_f32_32x32x16_bf16 a[48:63], v[28:31], v[20:23], a[48:63]
    s_waitcnt vmcnt(12)
    v_mfma_f32_32x32x16_bf16 a[0:15], v[40:43], v[32:35], a[0:15]
    v_mfma_f32_32x32x16_bf16 a[16:31], v[44:47], v[32:35], a[16:31]
    v_mfma_f32_32x32x16_bf16 a[32:47], v[40:43], v[36:39], a[32:47]
    v_mfma_f32_32x32x16_bf16 a[48:63], v[44:47], v[36:39], a[48:63]
    s_waitcnt vmcnt(8)
    v_mfma_f32_32x32x16_bf16 a[0:15], v[56:59], v[48:51], a[0:15]
    v_mfma_f32_32x32x16_bf16 a[16:31], v[60:63], v[48:51], a[16:31]
    v_mfma_f32_32x32x16_bf16 a[32:47], v[56:59], v[52:55], a[32:47]
    v_mfma_f32_32x32x16_bf16 a[48:63], v[60:63], v[52:55], a[48:63]
    s_waitcnt vmcnt(4)
    v_mfma_f32_32x32x16_bf16 a[0:15], v[72:75], v[64:67], a[0:15]
    v_mfma_f32_32x32x16_bf16 a[16:31], v[76:79], v[64:67], a[16:31]
    v_mfma_f32_32x32x16_bf16 a[32:47], v[72:75], v[68:71], a[32:47]
    v_mfma_f32_32x32x16_bf16 a[48:63], v[76:79], v[68:71], a[48:63]
    s_waitcnt vmcnt(0)
    v_mfma_f32_32x32x16_bf16 a[0:15], v[88:91], v[80:83], a[0:15]
    v_mfma_f32_32x32x16_bf16 a[16:31], v[92:95], v[80:83], a[16:31]
    v_mfma_f32_32x32x16_bf16 a[32:47], v[88:91], v[84:87], a[32:47]
    v_mfma_f32_32x32x16_bf16 a[48:63], v[92:95], v[84:87], a[48:63]
    s_nop 13
    s_lshl_b32 s57, s52, 14
    v_add_u32 v12, s57, v1
    ds_write_b128 v12, a[0:3] offset:0
    ds_write_b128 v12, a[4:7] offset:1024
    ds_write_b128 v12, a[8:11] offset:2048
    ds_write_b128 v12, a[12:15] offset:3072
    ds_write_b128 v12, a[16:19] offset:4096
    ds_write_b128 v12, a[20:23] offset:5120
    ds_write_b128 v12, a[24:27] offset:6144
    ds_write_b128 v12, a[28:31] offset:7168
    ds_write_b128 v12, a[32:35] offset:8192
    ds_write_b128 v12, a[36:39] offset:9216
    ds_write_b128 v12, a[40:43] offset:10240
    ds_write_b128 v12, a[44:47] offset:11264
    ds_write_b128 v12, a[48:51] offset:12288
    ds_write_b128 v12, a[52:55] offset:13312
    ds_write_b128 v12, a[56:59] offset:14336
    ds_write_b128 v12, a[60:63] offset:15360
    s_waitcnt lgkmcnt(0)
    s_barrier
    s_cmp_ge_u32 s52, 4
    s_cbranch_scc1 EP9_N
    s_add_u32 s57, s63, s81
    buffer_load_dwordx4 v[144:147], v13, s[28:31], s57 offen
    buffer_load_dwordx4 v[148:151], v13, s[28:31], s57 offen offset:512
    s_lshl_b32 s57, s52, 12
    v_add_u32 v12, s57, v1
    v_add_u32 v14, 0x10000, v12
    ds_read_b128 v[16:19], v12 offset:0
    ds_read_b128 v[20:23], v12 offset:1024
    ds_read_b128 v[24:27], v12 offset:2048
    ds_read_b128 v[28:31], v12 offset:3072
    ds_read_b128 v[32:35], v12 offset:16384
    ds_read_b128 v[36:39], v12 offset:17408
    ds_read_b128 v[40:43], v12 offset:18432
    ds_read_b128 v[44:47], v12 offset:19456
    ds_read_b128 v[48:51], v12 offset:32768
    ds_read_b128 v[52:55], v12 offset:33792
    ds_read_b128 v[56:59], v12 offset:34816
    ds_read_b128 v[60:63], v12 offset:35840
    ds_read_b128 v[64:67], v12 offset:49152
    ds_read_b128 v[68:71], v12 offset:50176
    ds_read_b128 v[72:75], v12 offset:51200
    ds_read_b128 v[76:79], v12 offset:52224
    ds_read_b128 v[80:83], v14 offset:0
    ds_read_b128 v[84:87], v14 offset:1024
    ds_read_b128 v[88:91], v14 offset:2048
    ds_read_b128 v[92:95], v14 offset:3072
    ds_read_b128 v[96:99], v14 offset:16384
    ds_read_b128 v[100:103], v14 offset:17408
    ds_read_b128 v[104:107], v14 offset:18432
    ds_read_b128 v[108:111], v14 offset:19456
    ds_read_b128 v[112:115], v14 offset:32768
    ds_read_b128 v[116:119], v14 offset:33792
    ds_read_b128 v[120:123], v14 offset:34816
    ds_read_b128 v[124:127], v14 offset:35840
    ds_read_b128 v[128:131], v14 offset:49152
    ds_read_b128 v[132:135], v14 offset:50176
    ds_read_b128 v[136:139], v14 offset:51200
    ds_read_b128 v[140:143], v14 offset:52224
    s_waitcnt vmcnt(0) lgkmcnt(0)
    v_pk_add_f32 v[16:17], v[16:17], v[80:81]
    v_pk_add_f32 v[18:19], v[18:19], v[82:83]
    v_pk_add_f32 v[20:21], v[20:21], v[84:85]
    v_pk_add_f32 v[22:23], v[22:23], v[86:87]
    v_pk_add_f32 v[24:25], v[24:25], v[88:89]
    v_pk_add_f32 v[26:27], v[26:27], v[90:91]
    v_pk_add_f32 v[28:29], v[28:29], v[92:93]
    v_pk_add_f32 v[30:31], v[30:31], v[94:95]
    v_pk_add_f32 v[32:33], v[32:33], v[96:97]
    v_pk_add_f32 v[34:35], v[34:35], v[98:99]
    v_pk_add_f32 v[36:37], v[36:37], v[100:101]
    v_pk_add_f32 v[38:39], v[38:39], v[102:103]
    v_pk_add_f32 v[40:41], v[40:41], v[104:105]
    v_pk_add_f32 v[42:43], v[42:43], v[106:107]
    v_pk_add_f32 v[44:45], v[44:45], v[108:109]
    v_pk_add_f32 v[46:47], v[46:47], v[110:111]
    v_pk_add_f32 v[48:49], v[48:49], v[112:113]
    v_pk_add_f32 v[50:51], v[50:51], v[114:115]
    v_pk_add_f32 v[52:53], v[52:53], v[116:117]
    v_pk_add_f32 v[54:55], v[54:55], v[118:119]
    v_pk_add_f32 v[56:57], v[56:57], v[120:121]
    v_pk_add_f32 v[58:59], v[58:59], v[122:123]
    v_pk_add_f32 v[60:61], v[60:61], v[124:125]
    v_pk_add_f32 v[62:63], v[62:63], v[126:127]
    v_pk_add_f32 v[64:65], v[64:65], v[128:129]
    v_pk_add_f32 v[66:67], v[66:67], v[130:131]
    v_pk_add_f32 v[68:69], v[68:69], v[132:133]
    v_pk_add_f32 v[70:71], v[70:71], v[134:135]
    v_pk_add_f32 v[72:73], v[72:73], v[136:137]
    v_pk_add_f32 v[74:75], v[74:75], v[138:139]
    v_pk_add_f32 v[76:77], v[76:77], v[140:141]
    v_pk_add_f32 v[78:79], v[78:79], v[142:143]
    v_pk_add_f32 v[16:17], v[16:17], v[48:49]
    v_pk_add_f32 v[18:19], v[18:19], v[50:51]
    v_pk_add_f32 v[20:21], v[20:21], v[52:53]
    v_pk_add_f32 v[22:23], v[22:23], v[54:55]
    v_pk_add_f32 v[24:25], v[24:25], v[56:57]
    v_pk_add_f32 v[26:27], v[26:27], v[58:59]
    v_pk_add_f32 v[28:29], v[28:29], v[60:61]
    v_pk_add_f32 v[30:31], v[30:31], v[62:63]
    v_pk_add_f32 v[32:33], v[32:33], v[64:65]
    v_pk_add_f32 v[34:35], v[34:35], v[66:67]
    v_pk_add_f32 v[36:37], v[36:37], v[68:69]
    v_pk_add_f32 v[38:39], v[38:39], v[70:71]
    v_pk_add_f32 v[40:41], v[40:41], v[72:73]
    v_pk_add_f32 v[42:43], v[42:43], v[74:75]
    v_pk_add_f32 v[44:45], v[44:45], v[76:77]
    v_pk_add_f32 v[46:47], v[46:47], v[78:79]
    v_pk_add_f32 v[16:17], v[16:17], v[32:33]
    v_pk_add_f32 v[18:19], v[18:19], v[34:35]
    v_pk_add_f32 v[20:21], v[20:21], v[36:37]
    v_pk_add_f32 v[22:23], v[22:23], v[38:39]
    v_pk_add_f32 v[24:25], v[24:25], v[40:41]
    v_pk_add_f32 v[26:27], v[26:27], v[42:43]
    v_pk_add_f32 v[28:29], v[28:29], v[44:45]
    v_pk_add_f32 v[30:31], v[30:31], v[46:47]
    v_cvt_pk_bf16_f32 v32, v16, v17
    v_cvt_pk_bf16_f32 v33, v18, v19
    v_cvt_pk_bf16_f32 v34, v20, v21
    v_cvt_pk_bf16_f32 v35, v22, v23
    v_cvt_pk_bf16_f32 v36, v24, v25
    v_cvt_pk_bf16_f32 v37, v26, v27
    v_cvt_pk_bf16_f32 v38, v28, v29
    v_cvt_pk_bf16_f32 v39, v30, v31
    v_lshlrev_b32 v16, 16, v32
    v_and_b32 v17, 0xffff0000, v32
    v_lshlrev_b32 v48, 16, v144
    v_and_b32 v49, 0xffff0000, v144
    v_lshlrev_b32 v18, 16, v33
    v_and_b32 v19, 0xffff0000, v33
    v_lshlrev_b32 v50, 16, v145
    v_and_b32 v51, 0xffff0000, v145
    v_lshlrev_b32 v20, 16, v34
    v_and_b32 v21, 0xffff0000, v34
    v_lshlrev_b32 v52, 16, v146
    v_and_b32 v53, 0xffff0000, v146
    v_lshlrev_b32 v22, 16, v35
    v_and_b32 v23, 0xffff0000, v35
    v_lshlrev_b32 v54, 16, v147
    v_and_b32 v55, 0xffff0000, v147
    v_lshlrev_b32 v24, 16, v36
    v_and_b32 v25, 0xffff0000, v36
    v_lshlrev_b32 v56, 16, v148
    v_and_b32 v57, 0xffff0000, v148
    v_lshlrev_b32 v26, 16, v37
    v_and_b32 v27, 0xffff0000, v37
    v_lshlrev_b32 v58, 16, v149
    v_and_b32 v59, 0xffff0000, v149
    v_lshlrev_b32 v28, 16, v38
    v_and_b32 v29, 0xffff0000, v38
    v_lshlrev_b32 v60, 16, v150
    v_and_b32 v61, 0xffff0000, v150
    v_lshlrev_b32 v30, 16, v39
    v_and_b32 v31, 0xffff0000, v39
    v_lshlrev_b32 v62, 16, v151
    v_and_b32 v63, 0xffff0000, v151
    v_pk_add_f32 v[16:17], v[16:17], v[48:49]
    v_pk_add_f32 v[18:19], v[18:19], v[50:51]
    v_pk_add_f32 v[20:21], v[20:21], v[52:53]
    v_pk_add_f32 v[22:23], v[22:23], v[54:55]
    v_pk_add_f32 v[24:25], v[24:25], v[56:57]
    v_pk_add_f32 v[26:27], v[26:27], v[58:59]
    v_pk_add_f32 v[28:29], v[28:29], v[60:61]
    v_pk_add_f32 v[30:31], v[30:31], v[62:63]
    v_cvt_pk_bf16_f32 v32, v16, v17
    v_cvt_pk_bf16_f32 v33, v18, v19
    v_cvt_pk_bf16_f32 v34, v20, v21
    v_cvt_pk_bf16_f32 v35, v22, v23
    v_cvt_pk_bf16_f32 v36, v24, v25
    v_cvt_pk_bf16_f32 v37, v26, v27
    v_cvt_pk_bf16_f32 v38, v28, v29
    v_cvt_pk_bf16_f32 v39, v30, v31
    s_cmp_eq_u32 s48, 0
    s_cbranch_scc1 EP9_NF
    s_mul_i32 s57, s62, 32*896
    s_lshl_b32 s59, s70, 7
    s_add_u32 s57, s57, s59
    s_and_b32 s59, s52, 1
    s_lshl_b32 s59, s59, 6
    s_add_u32 s57, s57, s59
    v_mul_u32_u24 v13, 896, v10
    v_lshl_add_u32 v13, v11, 5, v13
    buffer_store_dwordx4 v[32:35], v13, s[36:39], s57 offen
    buffer_store_dwordx4 v[36:39], v13, s[36:39], s57 offen offset:16
    s_endpgm
EP9_NF:
    s_add_u32 s57, s63, s82
    buffer_store_dwordx4 v[32:35], v13, s[28:31], s57 offen sc1
    buffer_store_dwordx4 v[36:39], v13, s[28:31], s57 offen offset:512 sc1
    v_lshlrev_b32 v16, 16, v32
    v_and_b32 v17, 0xffff0000, v32
    v_lshlrev_b32 v18, 16, v33
    v_and_b32 v19, 0xffff0000, v33
    v_lshlrev_b32 v20, 16, v34
    v_and_b32 v21, 0xffff0000, v34
    v_lshlrev_b32 v22, 16, v35
    v_and_b32 v23, 0xffff0000, v35
    v_lshlrev_b32 v24, 16, v36
    v_and_b32 v25, 0xffff0000, v36
    v_lshlrev_b32 v26, 16, v37
    v_and_b32 v27, 0xffff0000, v37
    v_lshlrev_b32 v28, 16, v38
    v_and_b32 v29, 0xffff0000, v38
    v_lshlrev_b32 v30, 16, v39
    v_and_b32 v31, 0xffff0000, v39
    v_pk_mul_f32 v[50:51], v[16:17], v[16:17]
    v_pk_add_f32 v[48:49], v[16:17], v[18:19]
    v_pk_fma_f32 v[50:51], v[18:19], v[18:19], v[50:51]
    v_pk_add_f32 v[48:49], v[48:49], v[20:21]
    v_pk_fma_f32 v[50:51], v[20:21], v[20:21], v[50:51]
    v_pk_add_f32 v[48:49], v[48:49], v[22:23]
    v_pk_fma_f32 v[50:51], v[22:23], v[22:23], v[50:51]
    v_pk_add_f32 v[48:49], v[48:49], v[24:25]
    v_pk_fma_f32 v[50:51], v[24:25], v[24:25], v[50:51]
    v_pk_add_f32 v[48:49], v[48:49], v[26:27]
    v_pk_fma_f32 v[50:51], v[26:27], v[26:27], v[50:51]
    v_pk_add_f32 v[48:49], v[48:49], v[28:29]
    v_pk_fma_f32 v[50:51], v[28:29], v[28:29], v[50:51]
    v_pk_add_f32 v[48:49], v[48:49], v[30:31]
    v_pk_fma_f32 v[50:51], v[30:31], v[30:31], v[50:51]
    v_add_f32 v48, v48, v49
    v_add_f32 v49, v50, v51
    s_nop 1
    v_permlane32_swap_b32 v48, v49
    s_nop 1
    v_add_f32 v48, v48, v49
    s_lshl_b32 s57, s62, 8
    s_add_u32 s57, s57, s88
    v_lshlrev_b32 v12, 3, v10
    v_lshl_add_u32 v12, v11, 2, v12
    buffer_atomic_add_f32 v48, v12, s[28:31], s57 offen
    s_waitcnt vmcnt(0) lgkmcnt(0)
    s_barrier
    s_cmp_lg_u32 s52, 0
    s_cbranch_scc1 EP9_S
    s_lshl_b32 s57, s54, 7
    s_add_u32 s57, s57, 7024640
    v_mov_b32 v3, 1
    v_mov_b32 v9, 0
    s_mov_b64 exec, 1
    buffer_atomic_add v3, v9, s[28:31], s57 offen sc1
    s_mov_b64 exec, -1
EP9_S:
    s_mul_i32 s57, s50, 384
    s_lshl_b32 s58, s76, 7
    s_add_u32 s58, s57, s58
    s_add_u32 s58, s58, 7290880
    s_add_u32 s57, s57, 7291136
    v_lshlrev_b32 v5, 4, v11
    buffer_load_dwordx4 v[64:67], v5, s[28:31], s58 offen offset:0
    buffer_load_dwordx4 v[68:71], v5, s[28:31], s58 offen offset:32
    buffer_load_dwordx4 v[72:75], v5, s[28:31], s58 offen offset:64
    buffer_load_dwordx4 v[76:79], v5, s[28:31], s58 offen offset:96
    buffer_load_dwordx4 v[80:83], v5, s[28:31], s57 offen offset:0
    buffer_load_dwordx4 v[84:87], v5, s[28:31], s57 offen offset:32
    buffer_load_dwordx4 v[88:91], v5, s[28:31], s57 offen offset:64
    buffer_load_dwordx4 v[92:95], v5, s[28:31], s57 offen offset:96
    s_lshl_b32 s57, s50, 11
    s_add_u32 s57, s57, 1376256
    buffer_load_dwordx4 a[64:67], v1, s[28:31], s57 offen
    buffer_load_dwordx4 a[68:71], v1, s[28:31], s57 offen offset:1024
    s_branch EP9_E
EP9_N:
    s_cmp_eq_u32 s48, 1
    s_cbranch_scc1 M_END
    s_mul_i32 s57, s50, 384
    s_lshl_b32 s58, s76, 7
    s_add_u32 s58, s57, s58
    s_add_u32 s58, s58, 7290880
    s_add_u32 s57, s57, 7291136
    v_lshlrev_b32 v5, 4, v11
    buffer_load_dwordx4 v[64:67], v5, s[28:31], s58 offen offset:0
    buffer_load_dwordx4 v[68:71], v5, s[28:31], s58 offen offset:32
    buffer_load_dwordx4 v[72:75], v5, s[28:31], s58 offen offset:64
    buffer_load_dwordx4 v[76:79], v5, s[28:31], s58 offen offset:96
    buffer_load_dwordx4 v[80:83], v5, s[28:31], s57 offen offset:0
    buffer_load_dwordx4 v[84:87], v5, s[28:31], s57 offen offset:32
    buffer_load_dwordx4 v[88:91], v5, s[28:31], s57 offen offset:64
    buffer_load_dwordx4 v[92:95], v5, s[28:31], s57 offen offset:96
    s_lshl_b32 s57, s50, 11
    s_add_u32 s57, s57, 1376256
    buffer_load_dwordx4 a[64:67], v1, s[28:31], s57 offen
    buffer_load_dwordx4 a[68:71], v1, s[28:31], s57 offen offset:1024
    s_barrier
EP9_E:
    s_branch M_NEXT
M_SKIP:
    s_cmp_eq_u32 s48, 1
    s_cbranch_scc1 M_END
    s_mul_i32 s57, s50, 384
    s_lshl_b32 s58, s76, 7
    s_add_u32 s58, s57, s58
    s_add_u32 s58, s58, 7290880
    s_add_u32 s57, s57, 7291136
    v_lshlrev_b32 v5, 4, v11
    buffer_load_dwordx4 v[64:67], v5, s[28:31], s58 offen offset:0
    buffer_load_dwordx4 v[68:71], v5, s[28:31], s58 offen offset:32
    buffer_load_dwordx4 v[72:75], v5, s[28:31], s58 offen offset:64
    buffer_load_dwordx4 v[76:79], v5, s[28:31], s58 offen offset:96
    buffer_load_dwordx4 v[80:83], v5, s[28:31], s57 offen offset:0
    buffer_load_dwordx4 v[84:87], v5, s[28:31], s57 offen offset:32
    buffer_load_dwordx4 v[88:91], v5, s[28:31], s57 offen offset:64
    buffer_load_dwordx4 v[92:95], v5, s[28:31], s57 offen offset:96
    s_lshl_b32 s57, s50, 11
    s_add_u32 s57, s57, 1376256
    buffer_load_dwordx4 a[64:67], v1, s[28:31], s57 offen
    buffer_load_dwordx4 a[68:71], v1, s[28:31], s57 offen offset:1024
    s_waitcnt vmcnt(0)
M_NEXT:
    s_mov_b32 s48, 1
    s_branch M_LOOP
M_END:
    s_endpgm
.section .rodata,"a"
.p2align 6
.amdhsa_kernel k0_kernel
  .amdhsa_next_free_vgpr 64
  .amdhsa_next_free_sgpr 48
  .amdhsa_accum_offset 64
  .amdhsa_group_segment_fixed_size 0
  .amdhsa_kernarg_size 88
  .amdhsa_user_sgpr_count 2
  .amdhsa_user_sgpr_kernarg_segment_ptr 1
  .amdhsa_system_sgpr_workgroup_id_x 1
.end_amdhsa_kernel
.p2align 6
.amdhsa_kernel mega_kernel
  .amdhsa_next_free_vgpr 256
  .amdhsa_next_free_sgpr 102
  .amdhsa_accum_offset 160
  .amdhsa_group_segment_fixed_size 0
  .amdhsa_kernarg_size 88
  .amdhsa_user_sgpr_count 2
  .amdhsa_user_sgpr_kernarg_segment_ptr 1
  .amdhsa_system_sgpr_workgroup_id_x 1
.end_amdhsa_kernel
```
